```python
import torch

def _softmax(x, axis=-1):
    return torch.softmax(x, dim=axis)
def _gelu(x):
    return torch.nn.functional.gelu(x, approximate="tanh")
def _silu(x):
    return torch.nn.functional.silu(x)
def _sigmoid(x):
    return torch.sigmoid(x)
def _layernorm(x, axis=-1, eps=1e-5):
    m = x.mean(dim=axis, keepdim=True)
    v = x.var(dim=axis, keepdim=True, unbiased=False)
    return (x - m) / torch.sqrt(v + eps)
def _scatter_add(tgt, idx, src, axis=0):
    return tgt.clone().index_add_(axis, idx, src)
def _segment_sum(src, seg, n):
    out = torch.zeros((n,) + src.shape[1:], dtype=src.dtype)
    return out.index_add_(0, seg, src)
def _pad(x, pw):
    flat = tuple(v for pair in reversed(pw) for v in pair)
    return torch.nn.functional.pad(x, flat)

kernel_name = 'standalone__gqa_block_cached__near_ridge'

def setup_inputs():

    _w = (lambda a: (lambda t: t.to(torch.bfloat16) if t.is_floating_point() else t)(torch.as_tensor(a)))
    B, Sq, D = 8, 160, 576
    Hq, Hkv, Sk, Dh = 32, 16, 2048, 128
    assert Hq % Hkv == 0, (Hq, Hkv)
    return {
        "x": _w((lambda *s: torch.randn(*s, dtype=torch.bfloat16) * 0.8)(B, Sq, D)),
        "k_cache": _w((lambda *s: torch.randn(*s, dtype=torch.bfloat16) * 0.8)(B, Hkv, Sk, Dh)),
        "v_cache": _w((lambda *s: torch.randn(*s, dtype=torch.bfloat16) * 0.05)(B, Hkv, Sk, Dh)),
        "wq": _w((lambda *s: torch.randn(*s, dtype=torch.bfloat16) * 0.8)(D, Hq * Dh) * (D ** -0.5)),
        "wo": _w((lambda *s: torch.randn(*s, dtype=torch.bfloat16) * 0.05)(Hq * Dh, D) * ((Hq * Dh) ** -0.5)),
    }

def reference(x, k_cache, v_cache, wq, wo):
    B, Sq, D = x.shape
    Hq, Dh = 32, 128
    Hkv = k_cache.shape[1]
    rep = Hq // Hkv
    q = (lambda x, *d: x.permute(*d))((x @ wq).reshape(B, Sq, Hq, Dh), 0, 2, 1, 3)
    k = (lambda x, n, axis: torch.repeat_interleave(x, n, dim=axis))(k_cache, rep, axis=1)
    v = (lambda x, n, axis: torch.repeat_interleave(x, n, dim=axis))(v_cache, rep, axis=1)
    scores = torch.einsum("bhqd,bhkd->bhqk", q, k) * (Dh ** -0.5)
    p = _softmax(scores, axis=-1)
    o = torch.einsum("bhqk,bhkd->bhqd", p, v)
    return (lambda x, *d: x.permute(*d))(o, 0, 2, 1, 3).reshape(B, Sq, Hq * Dh) @ wo
```

```asm
; @launch grid=(256,1,1) block=(256,1,1) lds=163840
.amdgcn_target "amdgcn-amd-amdhsa--gfx950"
.text
.globl standalone__gqa_block_cached__near_ridge_kernel
.p2align 8
.type standalone__gqa_block_cached__near_ridge_kernel,@function
standalone__gqa_block_cached__near_ridge_kernel:
  s_mov_b32 s58, 0
L_restart:
  s_load_dwordx4 s[4:7], s[0:1], 8
  s_load_dwordx2 s[8:9], s[0:1], 56
  s_load_dwordx2 s[40:41], s[0:1], 0
  s_load_dwordx2 s[44:45], s[0:1], 24
  s_load_dwordx2 s[92:93], s[0:1], 32
  s_load_dwordx2 s[88:89], s[0:1], 40
  s_load_dwordx2 s[84:85], s[0:1], 48
  s_cmp_ge_u32 s2, 256
  s_cbranch_scc1 L_a_end
  v_lshrrev_b32 v28, 6, v0
  v_and_b32 v17, 63, v0
  v_readfirstlane_b32 s24, v28
  s_and_b32 s3, s2, 7
  s_lshr_b32 s10, s2, 3
  s_mov_b32 s38, s3
  s_mov_b32 s37, s10
  s_and_b32 s11, s3, 1
  s_xor_b32 s11, s11, 0
  s_lshl_b32 s11, s11, 2
  s_lshr_b32 s35, s10, 3
  s_add_u32 s33, s11, s35
  s_lshr_b32 s11, s3, 1
  s_lshl_b32 s11, s11, 3
  s_and_b32 s35, s10, 7
  s_add_u32 s34, s11, s35
  s_lshr_b32 s25, s24, 1
  s_and_b32 s26, s24, 1
  s_lshl_b32 s27, s24, 11
  s_mul_i32 s57, s24, 5120
  s_lshl_b32 s11, s33, 4
  s_lshr_b32 s35, s34, 1
  s_add_u32 s11, s11, s35
  s_lshr_b32 s28, s11, 13
  s_lshl_b32 s35, s11, 19
  s_mul_i32 s10, s33, 184320
  s_lshl_b32 s11, s34, 8
  s_waitcnt lgkmcnt(0)
  s_add_u32 s40, s40, s10
  s_addc_u32 s41, s41, 0
  s_mov_b32 s42, 184320
  s_mov_b32 s43, 0x20000
  s_add_u32 s44, s44, s11
  s_addc_u32 s45, s45, 0
  s_sub_u32 s46, 4718592, s11
  s_mov_b32 s47, 0x20000
  s_mov_b32 s3, s35
  v_lshrrev_b32 v248, 4, v17
  v_and_b32 v249, 15, v17
  v_lshrrev_b32 v250, 3, v17
  v_and_b32 v251, 7, v17
  s_mul_i32 s35, s24, 46080
  s_and_b32 s36, s24, 1
  s_lshl_b32 s36, s36, 2
  v_mul_u32_u24 v252, 1152, v250
  v_add_u32 v252, s35, v252
  v_xor_b32 v253, v251, v248
  v_xor_b32 v253, s36, v253
  v_lshlrev_b32 v254, 4, v253
  v_add_u32 v18, v252, v254
  v_xor_b32 v254, 64, v254
  v_add_u32 v19, v252, v254
  v_or_b32 v252, s36, v248
  v_lshlrev_b32 v252, 1, v252
  v_xor_b32 v252, v252, v249
  v_lshlrev_b32 v252, 4, v252
  s_lshl_b32 s35, s24, 3
  v_add_u32 v253, s35, v248
  v_lshlrev_b32 v254, 13, v253
  v_add_u32 v20, v252, v254
  s_mov_b32 s48, 0
  s_mov_b32 s49, 8192
  s_mov_b32 s50, 16384
  s_mov_b32 s51, 24576
  s_mov_b32 s52, 36864
  s_mov_b32 s53, 0
  s_mov_b32 s54, 31744
  s_mov_b32 s55, 262144
  s_mov_b32 s56, 293888
  s_add_u32 m0, s57, 0x1f000
  v_mov_b64 v[240:241], 0
  buffer_load_dwordx4 v18, s[40:43], s48 offen lds
  buffer_load_dwordx4 v19, s[40:43], s49 offen offset:1024 lds
  buffer_load_dwordx4 v18, s[40:43], s50 offen offset:2048 lds
  buffer_load_dwordx4 v19, s[40:43], s51 offen offset:3072 lds
  s_add_u32 m0, s57, 0x20000
  v_mov_b64 v[242:243], 0
  buffer_load_dwordx4 v18, s[40:43], s52 offen lds
  s_add_u32 s48, s48, 128
  s_add_u32 s49, s49, 128
  s_add_u32 s50, s50, 128
  s_add_u32 s51, s51, 128
  s_add_u32 s52, s52, 128
  s_add_u32 m0, s27, 0x24000
  s_nop 1
  buffer_load_dwordx4 v20, s[44:47], s53 offen lds
  v_add_u32 v250, 0, v253
  v_and_b32 v251, 15, v250
  v_xor_b32 v251, v251, v249
  v_lshlrev_b32 v251, 4, v251
  v_lshlrev_b32 v252, 8, v250
  v_add_u32 v1, v251, v252
  v_and_b32 v251, 7, v250
  v_lshlrev_b32 v251, 1, v251
  v_xor_b32 v251, v251, v249
  v_lshlrev_b32 v251, 4, v251
  buffer_load_dwordx4 v20, s[44:47], s54 offen offset:1024 lds
  v_add_u32 v3, v251, v252
  v_add_u32 v250, 4, v253
  v_and_b32 v251, 15, v250
  v_xor_b32 v251, v251, v249
  v_lshlrev_b32 v251, 4, v251
  v_lshlrev_b32 v252, 8, v250
  v_add_u32 v2, v251, v252
  v_and_b32 v251, 7, v250
  v_lshlrev_b32 v251, 1, v251
  v_xor_b32 v251, v251, v249
  s_add_u32 m0, s27, 0x26000
  v_lshlrev_b32 v251, 4, v251
  buffer_load_dwordx4 v20, s[44:47], s55 offen lds
  v_mfma_f32_32x32x16_bf16 v[132:147], v[240:243], v[240:243], 0
  v_add_u32 v4, v251, v252
  v_subrev_u32 v2, 1024, v2
  v_subrev_u32 v4, 1024, v4
  s_add_u32 s12, s4, s3
  s_addc_u32 s13, s5, s28
  s_mov_b32 s14, 0x80000
  s_mov_b32 s15, 0x20000
  s_add_u32 s16, s6, s3
  s_addc_u32 s17, s7, s28
  buffer_load_dwordx4 v20, s[44:47], s56 offen offset:1024 lds
  s_mov_b32 s18, 0x80000
  s_mov_b32 s19, 0x20000
  s_mov_b32 s20, s8
  s_mov_b32 s21, s9
  s_mov_b32 s22, 0x10000000
  s_mov_b32 s23, 0x20000
  v_lshrrev_b32 v248, 4, v17
  v_and_b32 v249, 15, v17
  s_mul_i32 s35, s25, 10240
  s_add_u32 s35, s35, 0x4000
  s_add_u32 s53, s53, 0x80000
  s_add_u32 s54, s54, 0x80000
  s_add_u32 s55, s55, 0x80000
  s_add_u32 s56, s56, 0x80000
  s_add_u32 m0, s57, 0x4000
  v_lshrrev_b32 v250, 1, v249
  buffer_load_dwordx4 v18, s[40:43], s48 offen lds
  v_xor_b32 v250, v250, v248
  v_mfma_f32_32x32x16_bf16 v[148:163], v[240:243], v[240:243], 0
  v_lshlrev_b32 v250, 4, v250
  v_lshlrev_b32 v251, 7, v249
  v_add_u32 v251, s35, v251
  v_add_u32 v21, v250, v251
  v_xor_b32 v250, 64, v250
  v_add_u32 v22, v250, v251
  v_add_u32 v112, 0x12000, v21
  v_add_u32 v113, 0x12000, v22
  buffer_load_dwordx4 v19, s[40:43], s49 offen offset:1024 lds
  v_lshrrev_b32 v250, 2, v249
  v_and_b32 v251, 1, v248
  v_lshlrev_b32 v251, 2, v251
  v_or_b32 v251, v251, v250
  v_lshlrev_b32 v252, 3, v248
  v_add_u32 v252, v252, v250
  v_lshlrev_b32 v252, 8, v252
  v_and_b32 v253, 3, v17
  v_lshlrev_b32 v253, 3, v253
  v_add_u32 v252, v252, v253
  buffer_load_dwordx4 v18, s[40:43], s50 offen offset:2048 lds
  v_add_u32 v252, 0x9000, v252
  s_lshl_b32 s35, s26, 2
  v_xor_b32 v251, s35, v251
  v_mfma_f32_32x32x16_bf16 v[164:179], v[240:243], v[240:243], 0
  v_xor_b32 v253, 0, v251
  v_lshlrev_b32 v253, 5, v253
  v_add_u32 v23, v252, v253
  v_add_u32 v116, 0x12000, v23
  v_xor_b32 v253, 1, v251
  v_lshlrev_b32 v253, 5, v253
  buffer_load_dwordx4 v19, s[40:43], s51 offen offset:3072 lds
  v_add_u32 v24, v252, v253
  v_add_u32 v117, 0x12000, v24
  v_xor_b32 v253, 2, v251
  v_lshlrev_b32 v253, 5, v253
  v_add_u32 v25, v252, v253
  v_add_u32 v118, 0x12000, v25
  v_xor_b32 v253, 3, v251
  v_lshlrev_b32 v253, 5, v253
  v_add_u32 v26, v252, v253
  v_add_u32 v119, 0x12000, v26
  s_add_u32 m0, s57, 0x5000
  s_mul_i32 s35, s25, 20480
  buffer_load_dwordx4 v18, s[40:43], s52 offen lds
  s_lshl_b32 s36, s26, 11
  s_add_u32 s35, s35, s36
  s_add_u32 s35, s35, 0x1e000
  v_lshrrev_b32 v250, 1, v248
  v_mfma_f32_32x32x16_bf16 v[180:195], v[240:243], v[240:243], 0
  v_lshlrev_b32 v250, 8, v250
  v_lshlrev_b32 v251, 4, v249
  v_add_u32 v250, v250, v251
  v_and_b32 v251, 1, v248
  v_lshlrev_b32 v251, 3, v251
  s_add_u32 s48, s48, 128
  s_add_u32 s49, s49, 128
  s_add_u32 s50, s50, 128
  s_add_u32 s51, s51, 128
  s_add_u32 s52, s52, 128
  s_add_u32 m0, s27, 0x9000
  v_add_u32 v250, v250, v251
  buffer_load_dwordx4 v20, s[44:47], s53 offen lds
  v_add_u32 v27, s35, v250
  s_lshl_b32 s35, s26, 13
  v_add_u32 v250, 0, v248
  v_xor_b32 v250, v250, v249
  v_lshlrev_b32 v250, 4, v250
  v_lshlrev_b32 v251, 8, v249
  v_add_u32 v250, v250, v251
  v_add_u32 v5, s35, v250
  v_add_u32 v250, 4, v248
  v_xor_b32 v250, v250, v249
  buffer_load_dwordx4 v20, s[44:47], s54 offen offset:1024 lds
  v_lshlrev_b32 v250, 4, v250
  v_lshlrev_b32 v251, 8, v249
  v_add_u32 v250, v250, v251
  v_add_u32 v6, s35, v250
  v_add_u32 v250, 8, v248
  v_mfma_f32_32x32x16_bf16 v[196:211], v[240:243], v[240:243], 0
  v_xor_b32 v250, v250, v249
  v_lshlrev_b32 v250, 4, v250
  v_lshlrev_b32 v251, 8, v249
  v_add_u32 v250, v250, v251
  s_add_u32 m0, s27, 0xb000
  v_add_u32 v7, s35, v250
  buffer_load_dwordx4 v20, s[44:47], s55 offen lds
  v_add_u32 v250, 12, v248
  v_xor_b32 v250, v250, v249
  v_lshlrev_b32 v250, 4, v250
  v_lshlrev_b32 v251, 8, v249
  v_add_u32 v250, v250, v251
  v_add_u32 v8, s35, v250
  v_lshrrev_b32 v250, 2, v249
  v_lshlrev_b32 v251, 2, v248
  v_add_u32 v250, v250, v251
  v_and_b32 v251, 7, v250
  buffer_load_dwordx4 v20, s[44:47], s56 offen offset:1024 lds
  v_lshlrev_b32 v250, 8, v250
  v_and_b32 v252, 3, v17
  v_lshlrev_b32 v252, 3, v252
  v_add_u32 v250, v250, v252
  s_add_u32 s35, s35, 0x10000
  v_add_u32 v250, s35, v250
  v_mfma_f32_32x32x16_bf16 a[0:15], v[240:243], v[240:243], 0
  s_lshl_b32 s36, s26, 2
  v_xor_b32 v251, s36, v251
  v_xor_b32 v252, 0, v251
  s_add_u32 s53, s53, 0x80000
  s_add_u32 s54, s54, 0x80000
  s_add_u32 s55, s55, 0x80000
  s_add_u32 s56, s56, 0x80000
  s_add_u32 m0, s57, 0xd000
  v_lshlrev_b32 v252, 5, v252
  buffer_load_dwordx4 v18, s[40:43], s48 offen lds
  v_add_u32 v9, v250, v252
  v_xor_b32 v252, 1, v251
  v_lshlrev_b32 v252, 5, v252
  v_add_u32 v10, v250, v252
  v_xor_b32 v252, 2, v251
  v_lshlrev_b32 v252, 5, v252
  v_add_u32 v11, v250, v252
  v_xor_b32 v252, 3, v251
  v_lshlrev_b32 v252, 5, v252
  v_add_u32 v12, v250, v252
  buffer_load_dwordx4 v19, s[40:43], s49 offen offset:1024 lds
  v_xor_b32 v252, 4, v251
  v_lshlrev_b32 v252, 5, v252
  v_add_u32 v13, v250, v252
  v_xor_b32 v252, 5, v251
  v_lshlrev_b32 v252, 5, v252
  v_add_u32 v14, v250, v252
  v_xor_b32 v252, 6, v251
  v_mfma_f32_32x32x16_bf16 a[16:31], v[240:243], v[240:243], 0
  v_lshlrev_b32 v252, 5, v252
  v_add_u32 v15, v250, v252
  buffer_load_dwordx4 v18, s[40:43], s50 offen offset:2048 lds
  v_xor_b32 v252, 7, v251
  v_lshlrev_b32 v252, 5, v252
  v_add_u32 v16, v250, v252
  v_and_b32 v250, 3, v17
  v_cmp_eq_u32 vcc, 0, v250
  v_mov_b32 v251, 0x3f803f80
  s_mov_b32 s60, 0x3e0293ee
  s_mov_b32 s61, 0x3e0293ee
  v_cndmask_b32 v244, 0, v251, vcc
  v_cndmask_b32 v245, 0, v251, vcc
  buffer_load_dwordx4 v19, s[40:43], s51 offen offset:3072 lds
  v_cndmask_b32 v246, 0, v251, vcc
  v_cndmask_b32 v247, 0, v251, vcc
  s_mov_b32 s101, 0x73
  v_lshrrev_b32 v248, 5, v17
  v_mul_u32_u24 v248, 4352, v248
  v_lshrrev_b32 v249, 3, v17
  v_and_b32 v249, 3, v249
  v_mul_u32_u24 v249, 1088, v249
  v_add_u32 v248, v248, v249
  v_mfma_f32_32x32x16_bf16 a[32:47], v[240:243], v[240:243], 0
  s_add_u32 m0, s57, 0xe000
  v_lshrrev_b32 v249, 2, v17
  buffer_load_dwordx4 v18, s[40:43], s52 offen lds
  v_and_b32 v250, 1, v249
  v_lshlrev_b32 v251, 9, v250
  v_add_u32 v248, v248, v251
  v_xor_b32 v250, s24, v250
  v_lshlrev_b32 v250, 5, v250
  v_add_u32 v248, v248, v250
  v_and_b32 v250, 3, v17
  v_lshlrev_b32 v250, 3, v250
  v_add_u32 v248, v248, v250
  v_add_u32 v28, 0x20000, v248
  s_add_u32 s48, s48, 128
  s_add_u32 s49, s49, 128
  s_add_u32 s50, s50, 128
  s_add_u32 s51, s51, 128
  s_add_u32 s52, s52, 128
  s_add_u32 m0, s27, 0x12000
  v_lshlrev_b32 v249, 6, v249
  buffer_load_dwordx4 v20, s[44:47], s53 offen lds
  v_add_u32 v249, v249, v250
  s_lshl_b32 s35, s26, 5
  s_add_u32 s35, s35, 0x22400
  v_add_u32 v29, s35, v249
  v_lshlrev_b32 v30, 4, v17
  s_lshr_b32 s10, s2, 1
  s_and_b32 s11, s2, 1
  s_mul_i32 s11, s11, 18
  s_add_u32 s11, s11, s24
  v_mfma_f32_32x32x16_bf16 a[48:63], v[240:243], v[240:243], 0
  buffer_load_dwordx4 v20, s[44:47], s54 offen offset:1024 lds
  s_lshl_b32 s11, s11, 7
  s_add_u32 s11, s11, s10
  s_lshl_b32 s11, s11, 10
  s_add_u32 s96, s11, 0x1000000
  s_add_u32 s97, s96, 0x80000
  s_add_u32 s98, s97, 0x80000
  s_add_u32 s99, s98, 0x80000
  s_add_u32 s100, s99, 0x80000
  s_cmp_lt_u32 s24, 2
  s_cselect_b32 s100, s100, 0x10000000
  s_add_u32 m0, s27, 0x14000
  s_mul_i32 s10, s37, 43
  buffer_load_dwordx4 v20, s[44:47], s55 offen lds
  s_lshr_b32 s10, s10, 8
  s_lshr_b32 s11, s38, 1
  s_mul_i32 s11, s11, 5
  s_add_u32 s11, s11, s10
  s_mul_i32 s10, s10, 6
  s_sub_u32 s10, s37, s10
  s_and_b32 s35, s38, 1
  s_mul_i32 s35, s35, 6
  s_add_u32 s10, s10, s35
  s_lshl_b32 s4, s11, 19
  buffer_load_dwordx4 v20, s[44:47], s56 offen offset:1024 lds
  v_mfma_f32_32x32x16_bf16 a[64:79], v[240:243], v[240:243], 0
  s_mul_i32 s5, s10, 393216
  s_add_u32 s5, s5, 0x1000000
  s_mul_i32 s35, s11, 73728
  s_mul_i32 s36, s10, 96
  s_mov_b32 s6, s36
  s_add_u32 s35, s35, s36
  s_add_u32 s88, s88, s35
  s_addc_u32 s89, s89, 0
  s_sub_u32 s90, 1474560, s35
  s_add_u32 s53, s53, 0x80000
  s_add_u32 s54, s54, 0x80000
  s_add_u32 s55, s55, 0x80000
  s_add_u32 s56, s56, 0x80000
  s_add_u32 m0, s57, 0x16000
  s_mov_b32 s91, 0x20000
  buffer_load_dwordx4 v18, s[40:43], s48 offen lds
  s_mov_b32 s86, 256
  s_mov_b32 s87, 0x20000
  s_cmp_lt_u32 s37, 30
  s_cselect_b32 s9, 1, 0
  s_lshl_b32 s11, s11, 2
  s_mul_i32 s10, s11, 103
  s_lshr_b32 s10, s10, 10
  s_lshl_b32 s35, s10, 5
  s_add_u32 s35, s35, s37
  s_lshl_b32 s35, s35, 7
  buffer_load_dwordx4 v19, s[40:43], s49 offen offset:1024 lds
  s_add_u32 s7, s35, 0x2000000
  v_mfma_f32_32x32x16_bf16 a[80:95], v[240:243], v[240:243], 0
  s_add_u32 s11, s11, 3
  s_mul_i32 s10, s11, 103
  s_lshr_b32 s10, s10, 10
  s_lshl_b32 s35, s10, 5
  s_add_u32 s35, s35, s37
  s_lshl_b32 s35, s35, 7
  s_add_u32 s8, s35, 0x2000000
  s_lshl_b32 s39, s33, 12
  buffer_load_dwordx4 v18, s[40:43], s50 offen offset:2048 lds
  s_add_u32 s39, s39, 0x2000000
  s_lshl_b32 s10, s2, 7
  s_add_u32 s10, s10, 0x2000000
  s_cmp_lg_u32 s58, 0
  s_cselect_b32 s10, 0x10000000, s10
  v_and_b32 v248, 31, v17
  v_lshlrev_b32 v248, 2, v248
  v_mov_b32 v249, 0
  buffer_store_dword v249, v248, s[20:23], s10 offen sc1
  s_mul_i32 s35, s33, 10
  buffer_load_dwordx4 v19, s[40:43], s51 offen offset:3072 lds
  s_mul_i32 s36, s25, 5
  s_add_u32 s35, s35, s36
  s_lshl_b32 s35, s35, 5
  v_mfma_f32_16x16x32_bf16 a[96:99], v[240:243], v[240:243], 0
  s_add_u32 s35, s35, s34
  s_lshl_b32 s35, s35, 1
  s_add_u32 s35, s35, s26
  s_lshl_b32 s59, s35, 11
  s_lshr_b32 s10, s2, 1
  s_and_b32 s11, s2, 1
  s_add_u32 m0, s57, 0x17000
  s_mul_i32 s35, s10, 36864
  buffer_load_dwordx4 v18, s[40:43], s52 offen lds
  s_mul_i32 s36, s11, 576
  s_add_u32 s35, s35, s36
  s_add_u32 s92, s92, s35
  s_addc_u32 s93, s93, 0
  s_sub_u32 s94, 4718592, s35
  s_cmp_lg_u32 s58, 0
  s_cselect_b32 s94, 0, s94
  s_mov_b32 s95, 0x20000
  v_lshrrev_b32 v248, 5, v17
  v_and_b32 v249, 31, v17
  s_add_u32 s48, s48, 128
  s_add_u32 s49, s49, 128
  s_add_u32 s50, s50, 128
  s_add_u32 s51, s51, 128
  s_add_u32 s52, s52, 128
  s_add_u32 m0, s27, 0x1b000
  v_lshlrev_b32 v250, 1, v248
  buffer_load_dwordx4 v20, s[44:47], s53 offen lds
  v_xor_b32 v249, v249, v250
  v_lshlrev_b32 v249, 4, v249
  s_lshl_b32 s35, s24, 3
  v_add_u32 v248, s35, v248
  v_mul_u32_u24 v248, 1152, v248
  v_add_u32 v254, v248, v249
  v_lshrrev_b32 v250, 2, v17
  s_lshl_b32 s35, s26, 4
  v_add_u32 v250, s35, v250
  v_mul_u32_u24 v250, 1152, v250
  buffer_load_dwordx4 v20, s[44:47], s54 offen offset:1024 lds
  v_and_b32 v251, 3, v17
  v_lshlrev_b32 v251, 4, v251
  v_add_u32 v250, v250, v251
  v_add_u32 v255, 512, v250
  s_and_b32 s62, s37, 7
  s_lshl_b32 s62, s62, 2
  s_add_u32 s62, s62, s24
  s_mul_i32 s62, s62, 5760
  s_add_u32 s62, s62, 640
  v_mul_u32_u24 v32, 64, v17
  s_add_u32 m0, s27, 0x1d000
  v_lshrrev_b32 v32, 8, v32
  buffer_load_dwordx4 v20, s[44:47], s55 offen lds
  v_mul_u32_u24 v33, 640, v32
  v_lshlrev_b32 v32, 7, v17
  v_add_u32 v32, v32, v33
  s_lshr_b32 s63, s37, 3
  s_lshl_b32 s63, s63, 2
  s_add_u32 s63, s63, s24
  s_mul_i32 s63, s63, 131072
  s_add_u32 s63, s63, 2621440
  v_lshrrev_b32 v34, 1, v17
  v_lshlrev_b32 v34, 13, v34
  buffer_load_dwordx4 v20, s[44:47], s56 offen offset:1024 lds
  v_and_b32 v35, 1, v17
  v_lshlrev_b32 v35, 7, v35
  v_add_u32 v34, v34, v35
  s_add_u32 s53, s53, 0x80000
  s_add_u32 s54, s54, 0x80000
  s_add_u32 s55, s55, 0x80000
  s_add_u32 s56, s56, 0x80000
  s_mov_b32 exec_lo, 0xfffff
  s_mov_b32 exec_hi, 0
  buffer_load_dword a240, v32, s[40:43], s62 offen
  s_mov_b32 exec_lo, 0xffffffff
  s_mov_b32 exec_hi, 0
  buffer_load_dword a241, v34, s[44:47], s63 offen
  s_mov_b64 exec, -1
  s_getpc_b64 s[10:11]
L_ct_start:
  s_sub_u32 s10, s10, 0
  s_subb_u32 s11, s11, 0
  v_lshrrev_b32 v248, 6, v0
  s_lshl_b32 s3, s37, 2
  v_and_b32 v249, 0, v0
  v_add_u32 v248, s3, v248
  v_lshlrev_b32 v248, 0, v248
  v_add_u32 v248, v248, v249
  v_add_u32 v248, 4, v248
  v_min_u32 v248, 105, v248
  v_lshlrev_b32 v248, 7, v248
  v_mov_b32 v249, s11
  v_add_co_u32 v248, vcc, s10, v248
  v_addc_co_u32 v249, vcc, 0, v249, vcc
  s_mov_b64 exec, 1
  global_load_dword a255, v[248:249], off
  s_mov_b64 exec, -1
  s_waitcnt vmcnt(30)
  s_barrier
  ds_read_b128 a[132:135], v112 offset:36864
  ds_read_b64_tr_b16 v[212:213], v116 offset:36864
  ds_read_b64_tr_b16 v[214:215], v116 offset:37888
  ds_read_b128 a[136:139], v112 offset:38912
  ds_read_b128 a[140:143], v112 offset:40960
  ds_read_b128 a[144:147], v112 offset:43008
  ds_read_b128 a[148:151], v112 offset:45056
  ds_read_b64_tr_b16 v[216:217], v117 offset:36864
  ds_read_b64_tr_b16 v[218:219], v117 offset:37888
  ds_read_b64_tr_b16 v[220:221], v118 offset:36864
  ds_read_b64_tr_b16 v[222:223], v118 offset:37888
  ds_read_b64_tr_b16 v[224:225], v119 offset:36864
  ds_read_b64_tr_b16 v[226:227], v119 offset:37888
  s_waitcnt lgkmcnt(0)
  v_mfma_f32_16x16x32_bf16 v[32:35], v[212:215], a[132:135], 0
  ds_read_b128 a[152:155], v113 offset:36864
  v_mfma_f32_16x16x32_bf16 v[48:51], v[212:215], a[136:139], 0
  ds_read_b64_tr_b16 v[228:229], v116 offset:45056
  ds_read_b64_tr_b16 v[230:231], v116 offset:46080
  v_mfma_f32_16x16x32_bf16 v[64:67], v[212:215], a[140:143], 0
  ds_read_b128 a[156:159], v113 offset:38912
  v_mfma_f32_16x16x32_bf16 v[80:83], v[212:215], a[144:147], 0
  ds_read_b128 a[160:163], v113 offset:40960
  v_mfma_f32_16x16x32_bf16 v[96:99], v[212:215], a[148:151], 0
  ds_read_b128 a[164:167], v113 offset:43008
  v_mfma_f32_16x16x32_bf16 v[36:39], v[216:219], a[132:135], 0
  ds_read_b128 a[168:171], v113 offset:45056
  v_mfma_f32_16x16x32_bf16 v[52:55], v[216:219], a[136:139], 0
  ds_read_b64_tr_b16 v[232:233], v117 offset:45056
  ds_read_b64_tr_b16 v[234:235], v117 offset:46080
  v_mfma_f32_16x16x32_bf16 v[68:71], v[216:219], a[140:143], 0
  ds_read_b64_tr_b16 v[236:237], v118 offset:45056
  ds_read_b64_tr_b16 v[238:239], v118 offset:46080
  v_mfma_f32_16x16x32_bf16 v[84:87], v[216:219], a[144:147], 0
  ds_read_b64_tr_b16 v[240:241], v119 offset:45056
  ds_read_b64_tr_b16 v[242:243], v119 offset:46080
  v_mfma_f32_16x16x32_bf16 v[100:103], v[216:219], a[148:151], 0
  v_mfma_f32_16x16x32_bf16 v[40:43], v[220:223], a[132:135], 0
  v_mfma_f32_16x16x32_bf16 v[56:59], v[220:223], a[136:139], 0
  v_mfma_f32_16x16x32_bf16 v[72:75], v[220:223], a[140:143], 0
  v_mfma_f32_16x16x32_bf16 v[88:91], v[220:223], a[144:147], 0
  v_mfma_f32_16x16x32_bf16 v[104:107], v[220:223], a[148:151], 0
  v_mfma_f32_16x16x32_bf16 v[44:47], v[224:227], a[132:135], 0
  v_mfma_f32_16x16x32_bf16 v[60:63], v[224:227], a[136:139], 0
  v_mfma_f32_16x16x32_bf16 v[76:79], v[224:227], a[140:143], 0
  v_mfma_f32_16x16x32_bf16 v[92:95], v[224:227], a[144:147], 0
  v_mfma_f32_16x16x32_bf16 v[108:111], v[224:227], a[148:151], 0
  s_waitcnt vmcnt(21) lgkmcnt(0)
  s_barrier
  v_mfma_f32_16x16x32_bf16 v[32:35], v[228:231], a[152:155], v[32:35]
  ds_read_b128 a[132:135], v21 offset:0
  v_mfma_f32_16x16x32_bf16 v[48:51], v[228:231], a[156:159], v[48:51]
  ds_read_b64_tr_b16 v[212:213], v23 offset:0
  ds_read_b64_tr_b16 v[214:215], v23 offset:1024
  v_mfma_f32_16x16x32_bf16 v[64:67], v[228:231], a[160:163], v[64:67]
  ds_read_b128 a[136:139], v21 offset:2048
  v_mfma_f32_16x16x32_bf16 v[80:83], v[228:231], a[164:167], v[80:83]
  ds_read_b128 a[140:143], v21 offset:4096
  v_mfma_f32_16x16x32_bf16 v[96:99], v[228:231], a[168:171], v[96:99]
  ds_read_b128 a[144:147], v21 offset:6144
  v_mfma_f32_16x16x32_bf16 v[36:39], v[232:235], a[152:155], v[36:39]
  ds_read_b128 a[148:151], v21 offset:8192
  v_mfma_f32_16x16x32_bf16 v[52:55], v[232:235], a[156:159], v[52:55]
  ds_read_b64_tr_b16 v[216:217], v24 offset:0
  ds_read_b64_tr_b16 v[218:219], v24 offset:1024
  v_mfma_f32_16x16x32_bf16 v[68:71], v[232:235], a[160:163], v[68:71]
  ds_read_b64_tr_b16 v[220:221], v25 offset:0
  ds_read_b64_tr_b16 v[222:223], v25 offset:1024
  v_mfma_f32_16x16x32_bf16 v[84:87], v[232:235], a[164:167], v[84:87]
  ds_read_b64_tr_b16 v[224:225], v26 offset:0
  ds_read_b64_tr_b16 v[226:227], v26 offset:1024
  v_mfma_f32_16x16x32_bf16 v[100:103], v[232:235], a[168:171], v[100:103]
  s_add_u32 m0, s57, 0x1f000
  v_mfma_f32_16x16x32_bf16 v[40:43], v[236:239], a[152:155], v[40:43]
  buffer_load_dwordx4 v18, s[40:43], s48 offen lds
  v_mfma_f32_16x16x32_bf16 v[56:59], v[236:239], a[156:159], v[56:59]
  v_mfma_f32_16x16x32_bf16 v[72:75], v[236:239], a[160:163], v[72:75]
  buffer_load_dwordx4 v19, s[40:43], s49 offen offset:1024 lds
  v_mfma_f32_16x16x32_bf16 v[88:91], v[236:239], a[164:167], v[88:91]
  v_mfma_f32_16x16x32_bf16 v[104:107], v[236:239], a[168:171], v[104:107]
  buffer_load_dwordx4 v18, s[40:43], s50 offen offset:2048 lds
  v_mfma_f32_16x16x32_bf16 v[44:47], v[240:243], a[152:155], v[44:47]
  v_mfma_f32_16x16x32_bf16 v[60:63], v[240:243], a[156:159], v[60:63]
  buffer_load_dwordx4 v19, s[40:43], s51 offen offset:3072 lds
  v_mfma_f32_16x16x32_bf16 v[76:79], v[240:243], a[160:163], v[76:79]
  s_add_u32 m0, s57, 0x20000
  v_mfma_f32_16x16x32_bf16 v[92:95], v[240:243], a[164:167], v[92:95]
  buffer_load_dwordx4 v18, s[40:43], s52 offen lds
  v_mfma_f32_16x16x32_bf16 v[108:111], v[240:243], a[168:171], v[108:111]
  s_waitcnt lgkmcnt(0)
  v_mfma_f32_16x16x32_bf16 v[32:35], v[212:215], a[132:135], v[32:35]
  s_add_u32 s48, s48, 128
  ds_read_b128 a[152:155], v22 offset:0
  v_mfma_f32_16x16x32_bf16 v[48:51], v[212:215], a[136:139], v[48:51]
  s_add_u32 s49, s49, 128
  ds_read_b64_tr_b16 v[228:229], v23 offset:8192
  ds_read_b64_tr_b16 v[230:231], v23 offset:9216
  v_mfma_f32_16x16x32_bf16 v[64:67], v[212:215], a[140:143], v[64:67]
  s_add_u32 s50, s50, 128
  ds_read_b128 a[156:159], v22 offset:2048
  v_mfma_f32_16x16x32_bf16 v[80:83], v[212:215], a[144:147], v[80:83]
  s_add_u32 s51, s51, 128
  ds_read_b128 a[160:163], v22 offset:4096
  v_mfma_f32_16x16x32_bf16 v[96:99], v[212:215], a[148:151], v[96:99]
  s_add_u32 s52, s52, 128
  ds_read_b128 a[164:167], v22 offset:6144
  v_mfma_f32_16x16x32_bf16 v[36:39], v[216:219], a[132:135], v[36:39]
  ds_read_b128 a[168:171], v22 offset:8192
  v_mfma_f32_16x16x32_bf16 v[52:55], v[216:219], a[136:139], v[52:55]
  ds_read_b64_tr_b16 v[232:233], v24 offset:8192
  ds_read_b64_tr_b16 v[234:235], v24 offset:9216
  v_mfma_f32_16x16x32_bf16 v[68:71], v[216:219], a[140:143], v[68:71]
  ds_read_b64_tr_b16 v[236:237], v25 offset:8192
  ds_read_b64_tr_b16 v[238:239], v25 offset:9216
  v_mfma_f32_16x16x32_bf16 v[84:87], v[216:219], a[144:147], v[84:87]
  ds_read_b64_tr_b16 v[240:241], v26 offset:8192
  ds_read_b64_tr_b16 v[242:243], v26 offset:9216
  v_mfma_f32_16x16x32_bf16 v[100:103], v[216:219], a[148:151], v[100:103]
  s_add_u32 m0, s27, 0x24000
  v_mfma_f32_16x16x32_bf16 v[40:43], v[220:223], a[132:135], v[40:43]
  buffer_load_dwordx4 v20, s[44:47], s53 offen lds
  v_mfma_f32_16x16x32_bf16 v[56:59], v[220:223], a[136:139], v[56:59]
  v_mfma_f32_16x16x32_bf16 v[72:75], v[220:223], a[140:143], v[72:75]
  buffer_load_dwordx4 v20, s[44:47], s54 offen offset:1024 lds
  v_mfma_f32_16x16x32_bf16 v[88:91], v[220:223], a[144:147], v[88:91]
  s_add_u32 m0, s27, 0x26000
  v_mfma_f32_16x16x32_bf16 v[104:107], v[220:223], a[148:151], v[104:107]
  buffer_load_dwordx4 v20, s[44:47], s55 offen lds
  v_mfma_f32_16x16x32_bf16 v[44:47], v[224:227], a[132:135], v[44:47]
  v_mfma_f32_16x16x32_bf16 v[60:63], v[224:227], a[136:139], v[60:63]
  buffer_load_dwordx4 v20, s[44:47], s56 offen offset:1024 lds
  v_mfma_f32_16x16x32_bf16 v[76:79], v[224:227], a[140:143], v[76:79]
  v_mfma_f32_16x16x32_bf16 v[92:95], v[224:227], a[144:147], v[92:95]
  v_mfma_f32_16x16x32_bf16 v[108:111], v[224:227], a[148:151], v[108:111]
  s_waitcnt vmcnt(21) lgkmcnt(0)
  s_barrier
  v_mfma_f32_16x16x32_bf16 v[32:35], v[228:231], a[152:155], v[32:35]
  s_add_u32 s53, s53, 0x80000
  ds_read_b128 a[132:135], v21 offset:36864
  v_mfma_f32_16x16x32_bf16 v[48:51], v[228:231], a[156:159], v[48:51]
  s_add_u32 s54, s54, 0x80000
  ds_read_b64_tr_b16 v[212:213], v23 offset:36864
  ds_read_b64_tr_b16 v[214:215], v23 offset:37888
  v_mfma_f32_16x16x32_bf16 v[64:67], v[228:231], a[160:163], v[64:67]
  s_add_u32 s55, s55, 0x80000
  ds_read_b128 a[136:139], v21 offset:38912
  v_mfma_f32_16x16x32_bf16 v[80:83], v[228:231], a[164:167], v[80:83]
  s_add_u32 s56, s56, 0x80000
  ds_read_b128 a[140:143], v21 offset:40960
  v_mfma_f32_16x16x32_bf16 v[96:99], v[228:231], a[168:171], v[96:99]
  ds_read_b128 a[144:147], v21 offset:43008
  v_mfma_f32_16x16x32_bf16 v[36:39], v[232:235], a[152:155], v[36:39]
  ds_read_b128 a[148:151], v21 offset:45056
  v_mfma_f32_16x16x32_bf16 v[52:55], v[232:235], a[156:159], v[52:55]
  ds_read_b64_tr_b16 v[216:217], v24 offset:36864
  ds_read_b64_tr_b16 v[218:219], v24 offset:37888
  v_mfma_f32_16x16x32_bf16 v[68:71], v[232:235], a[160:163], v[68:71]
  ds_read_b64_tr_b16 v[220:221], v25 offset:36864
  ds_read_b64_tr_b16 v[222:223], v25 offset:37888
  v_mfma_f32_16x16x32_bf16 v[84:87], v[232:235], a[164:167], v[84:87]
  ds_read_b64_tr_b16 v[224:225], v26 offset:36864
  ds_read_b64_tr_b16 v[226:227], v26 offset:37888
  v_mfma_f32_16x16x32_bf16 v[100:103], v[232:235], a[168:171], v[100:103]
  s_add_u32 m0, s57, 0x4000
  v_mfma_f32_16x16x32_bf16 v[40:43], v[236:239], a[152:155], v[40:43]
  buffer_load_dwordx4 v18, s[40:43], s48 offen lds
  v_mfma_f32_16x16x32_bf16 v[56:59], v[236:239], a[156:159], v[56:59]
  v_mfma_f32_16x16x32_bf16 v[72:75], v[236:239], a[160:163], v[72:75]
  buffer_load_dwordx4 v19, s[40:43], s49 offen offset:1024 lds
  v_mfma_f32_16x16x32_bf16 v[88:91], v[236:239], a[164:167], v[88:91]
  v_mfma_f32_16x16x32_bf16 v[104:107], v[236:239], a[168:171], v[104:107]
  buffer_load_dwordx4 v18, s[40:43], s50 offen offset:2048 lds
  v_mfma_f32_16x16x32_bf16 v[44:47], v[240:243], a[152:155], v[44:47]
  v_mfma_f32_16x16x32_bf16 v[60:63], v[240:243], a[156:159], v[60:63]
  buffer_load_dwordx4 v19, s[40:43], s51 offen offset:3072 lds
  v_mfma_f32_16x16x32_bf16 v[76:79], v[240:243], a[160:163], v[76:79]
  s_add_u32 m0, s57, 0x5000
  v_mfma_f32_16x16x32_bf16 v[92:95], v[240:243], a[164:167], v[92:95]
  buffer_load_dwordx4 v18, s[40:43], s52 offen lds
  v_mfma_f32_16x16x32_bf16 v[108:111], v[240:243], a[168:171], v[108:111]
  s_waitcnt lgkmcnt(0)
  v_mfma_f32_16x16x32_bf16 v[32:35], v[212:215], a[132:135], v[32:35]
  s_add_u32 s48, s48, 128
  ds_read_b128 a[152:155], v22 offset:36864
  v_mfma_f32_16x16x32_bf16 v[48:51], v[212:215], a[136:139], v[48:51]
  s_add_u32 s49, s49, 128
  ds_read_b64_tr_b16 v[228:229], v23 offset:45056
  ds_read_b64_tr_b16 v[230:231], v23 offset:46080
  v_mfma_f32_16x16x32_bf16 v[64:67], v[212:215], a[140:143], v[64:67]
  s_add_u32 s50, s50, 128
  ds_read_b128 a[156:159], v22 offset:38912
  v_mfma_f32_16x16x32_bf16 v[80:83], v[212:215], a[144:147], v[80:83]
  s_add_u32 s51, s51, 128
  ds_read_b128 a[160:163], v22 offset:40960
  v_mfma_f32_16x16x32_bf16 v[96:99], v[212:215], a[148:151], v[96:99]
  s_add_u32 s52, s52, 128
  ds_read_b128 a[164:167], v22 offset:43008
  v_mfma_f32_16x16x32_bf16 v[36:39], v[216:219], a[132:135], v[36:39]
  ds_read_b128 a[168:171], v22 offset:45056
  v_mfma_f32_16x16x32_bf16 v[52:55], v[216:219], a[136:139], v[52:55]
  ds_read_b64_tr_b16 v[232:233], v24 offset:45056
  ds_read_b64_tr_b16 v[234:235], v24 offset:46080
  v_mfma_f32_16x16x32_bf16 v[68:71], v[216:219], a[140:143], v[68:71]
  ds_read_b64_tr_b16 v[236:237], v25 offset:45056
  ds_read_b64_tr_b16 v[238:239], v25 offset:46080
  v_mfma_f32_16x16x32_bf16 v[84:87], v[216:219], a[144:147], v[84:87]
  ds_read_b64_tr_b16 v[240:241], v26 offset:45056
  ds_read_b64_tr_b16 v[242:243], v26 offset:46080
  v_mfma_f32_16x16x32_bf16 v[100:103], v[216:219], a[148:151], v[100:103]
  s_add_u32 m0, s27, 0x9000
  v_mfma_f32_16x16x32_bf16 v[40:43], v[220:223], a[132:135], v[40:43]
  buffer_load_dwordx4 v20, s[44:47], s53 offen lds
  v_mfma_f32_16x16x32_bf16 v[56:59], v[220:223], a[136:139], v[56:59]
  v_mfma_f32_16x16x32_bf16 v[72:75], v[220:223], a[140:143], v[72:75]
  buffer_load_dwordx4 v20, s[44:47], s54 offen offset:1024 lds
  v_mfma_f32_16x16x32_bf16 v[88:91], v[220:223], a[144:147], v[88:91]
  s_add_u32 m0, s27, 0xb000
  v_mfma_f32_16x16x32_bf16 v[104:107], v[220:223], a[148:151], v[104:107]
  buffer_load_dwordx4 v20, s[44:47], s55 offen lds
  v_mfma_f32_16x16x32_bf16 v[44:47], v[224:227], a[132:135], v[44:47]
  v_mfma_f32_16x16x32_bf16 v[60:63], v[224:227], a[136:139], v[60:63]
  buffer_load_dwordx4 v20, s[44:47], s56 offen offset:1024 lds
  v_mfma_f32_16x16x32_bf16 v[76:79], v[224:227], a[140:143], v[76:79]
  v_mfma_f32_16x16x32_bf16 v[92:95], v[224:227], a[144:147], v[92:95]
  v_mfma_f32_16x16x32_bf16 v[108:111], v[224:227], a[148:151], v[108:111]
  s_waitcnt vmcnt(20) lgkmcnt(0)
  s_barrier
  v_mfma_f32_16x16x32_bf16 v[32:35], v[228:231], a[152:155], v[32:35]
  s_add_u32 s53, s53, 0x80000
  ds_read_b128 a[132:135], v112 offset:0
  v_mfma_f32_16x16x32_bf16 v[48:51], v[228:231], a[156:159], v[48:51]
  s_add_u32 s54, s54, 0x80000
  ds_read_b64_tr_b16 v[212:213], v116 offset:0
  ds_read_b64_tr_b16 v[214:215], v116 offset:1024
  v_mfma_f32_16x16x32_bf16 v[64:67], v[228:231], a[160:163], v[64:67]
  s_add_u32 s55, s55, 0x80000
  ds_read_b128 a[136:139], v112 offset:2048
  v_mfma_f32_16x16x32_bf16 v[80:83], v[228:231], a[164:167], v[80:83]
  s_add_u32 s56, s56, 0x80000
  ds_read_b128 a[140:143], v112 offset:4096
  v_mfma_f32_16x16x32_bf16 v[96:99], v[228:231], a[168:171], v[96:99]
  ds_read_b128 a[144:147], v112 offset:6144
  v_mfma_f32_16x16x32_bf16 v[36:39], v[232:235], a[152:155], v[36:39]
  ds_read_b128 a[148:151], v112 offset:8192
  v_mfma_f32_16x16x32_bf16 v[52:55], v[232:235], a[156:159], v[52:55]
  ds_read_b64_tr_b16 v[216:217], v117 offset:0
  ds_read_b64_tr_b16 v[218:219], v117 offset:1024
  v_mfma_f32_16x16x32_bf16 v[68:71], v[232:235], a[160:163], v[68:71]
  ds_read_b64_tr_b16 v[220:221], v118 offset:0
  ds_read_b64_tr_b16 v[222:223], v118 offset:1024
  v_mfma_f32_16x16x32_bf16 v[84:87], v[232:235], a[164:167], v[84:87]
  ds_read_b64_tr_b16 v[224:225], v119 offset:0
  ds_read_b64_tr_b16 v[226:227], v119 offset:1024
  v_mfma_f32_16x16x32_bf16 v[100:103], v[232:235], a[168:171], v[100:103]
  s_add_u32 m0, s57, 0xd000
  v_mfma_f32_16x16x32_bf16 v[40:43], v[236:239], a[152:155], v[40:43]
  buffer_load_dwordx4 v18, s[40:43], s48 offen lds
  v_mfma_f32_16x16x32_bf16 v[56:59], v[236:239], a[156:159], v[56:59]
  v_mfma_f32_16x16x32_bf16 v[72:75], v[236:239], a[160:163], v[72:75]
  buffer_load_dwordx4 v19, s[40:43], s49 offen offset:1024 lds
  v_mfma_f32_16x16x32_bf16 v[88:91], v[236:239], a[164:167], v[88:91]
  v_mfma_f32_16x16x32_bf16 v[104:107], v[236:239], a[168:171], v[104:107]
  buffer_load_dwordx4 v18, s[40:43], s50 offen offset:2048 lds
  v_mfma_f32_16x16x32_bf16 v[44:47], v[240:243], a[152:155], v[44:47]
  v_mfma_f32_16x16x32_bf16 v[60:63], v[240:243], a[156:159], v[60:63]
  buffer_load_dwordx4 v19, s[40:43], s51 offen offset:3072 lds
  v_mfma_f32_16x16x32_bf16 v[76:79], v[240:243], a[160:163], v[76:79]
  s_add_u32 m0, s57, 0xe000
  v_mfma_f32_16x16x32_bf16 v[92:95], v[240:243], a[164:167], v[92:95]
  buffer_load_dwordx4 v18, s[40:43], s52 offen lds
  v_mfma_f32_16x16x32_bf16 v[108:111], v[240:243], a[168:171], v[108:111]
  s_waitcnt lgkmcnt(0)
  v_mfma_f32_16x16x32_bf16 v[32:35], v[212:215], a[132:135], v[32:35]
  s_add_u32 s48, s48, 128
  ds_read_b128 a[152:155], v113 offset:0
  v_mfma_f32_16x16x32_bf16 v[48:51], v[212:215], a[136:139], v[48:51]
  s_add_u32 s49, s49, 128
  ds_read_b64_tr_b16 v[228:229], v116 offset:8192
  ds_read_b64_tr_b16 v[230:231], v116 offset:9216
  v_mfma_f32_16x16x32_bf16 v[64:67], v[212:215], a[140:143], v[64:67]
  s_add_u32 s50, s50, 128
  ds_read_b128 a[156:159], v113 offset:2048
  v_mfma_f32_16x16x32_bf16 v[80:83], v[212:215], a[144:147], v[80:83]
  s_add_u32 s51, s51, 128
  ds_read_b128 a[160:163], v113 offset:4096
  v_mfma_f32_16x16x32_bf16 v[96:99], v[212:215], a[148:151], v[96:99]
  s_add_u32 s52, s52, 128
  ds_read_b128 a[164:167], v113 offset:6144
  v_mfma_f32_16x16x32_bf16 v[36:39], v[216:219], a[132:135], v[36:39]
  ds_read_b128 a[168:171], v113 offset:8192
  v_mfma_f32_16x16x32_bf16 v[52:55], v[216:219], a[136:139], v[52:55]
  ds_read_b64_tr_b16 v[232:233], v117 offset:8192
  ds_read_b64_tr_b16 v[234:235], v117 offset:9216
  v_mfma_f32_16x16x32_bf16 v[68:71], v[216:219], a[140:143], v[68:71]
  ds_read_b64_tr_b16 v[236:237], v118 offset:8192
  ds_read_b64_tr_b16 v[238:239], v118 offset:9216
  v_mfma_f32_16x16x32_bf16 v[84:87], v[216:219], a[144:147], v[84:87]
  ds_read_b64_tr_b16 v[240:241], v119 offset:8192
  ds_read_b64_tr_b16 v[242:243], v119 offset:9216
  v_mfma_f32_16x16x32_bf16 v[100:103], v[216:219], a[148:151], v[100:103]
  s_add_u32 m0, s27, 0x12000
  v_mfma_f32_16x16x32_bf16 v[40:43], v[220:223], a[132:135], v[40:43]
  buffer_load_dwordx4 v20, s[44:47], s53 offen lds
  v_mfma_f32_16x16x32_bf16 v[56:59], v[220:223], a[136:139], v[56:59]
  v_mfma_f32_16x16x32_bf16 v[72:75], v[220:223], a[140:143], v[72:75]
  buffer_load_dwordx4 v20, s[44:47], s54 offen offset:1024 lds
  v_mfma_f32_16x16x32_bf16 v[88:91], v[220:223], a[144:147], v[88:91]
  s_add_u32 m0, s27, 0x14000
  v_mfma_f32_16x16x32_bf16 v[104:107], v[220:223], a[148:151], v[104:107]
  buffer_load_dwordx4 v20, s[44:47], s55 offen lds
  v_mfma_f32_16x16x32_bf16 v[44:47], v[224:227], a[132:135], v[44:47]
  v_mfma_f32_16x16x32_bf16 v[60:63], v[224:227], a[136:139], v[60:63]
  buffer_load_dwordx4 v20, s[44:47], s56 offen offset:1024 lds
  v_mfma_f32_16x16x32_bf16 v[76:79], v[224:227], a[140:143], v[76:79]
  v_mfma_f32_16x16x32_bf16 v[92:95], v[224:227], a[144:147], v[92:95]
  v_mfma_f32_16x16x32_bf16 v[108:111], v[224:227], a[148:151], v[108:111]
  s_waitcnt vmcnt(18) lgkmcnt(0)
  s_barrier
  v_mfma_f32_16x16x32_bf16 v[32:35], v[228:231], a[152:155], v[32:35]
  s_add_u32 s53, s53, 0x80000
  ds_read_b128 a[132:135], v112 offset:36864
  v_mfma_f32_16x16x32_bf16 v[48:51], v[228:231], a[156:159], v[48:51]
  s_add_u32 s54, s54, 0x80000
  ds_read_b64_tr_b16 v[212:213], v116 offset:36864
  ds_read_b64_tr_b16 v[214:215], v116 offset:37888
  v_mfma_f32_16x16x32_bf16 v[64:67], v[228:231], a[160:163], v[64:67]
  s_add_u32 s55, s55, 0x80000
  ds_read_b128 a[136:139], v112 offset:38912
  v_mfma_f32_16x16x32_bf16 v[80:83], v[228:231], a[164:167], v[80:83]
  s_add_u32 s56, s56, 0x80000
  ds_read_b128 a[140:143], v112 offset:40960
  v_mfma_f32_16x16x32_bf16 v[96:99], v[228:231], a[168:171], v[96:99]
  ds_read_b128 a[144:147], v112 offset:43008
  v_mfma_f32_16x16x32_bf16 v[36:39], v[232:235], a[152:155], v[36:39]
  ds_read_b128 a[148:151], v112 offset:45056
  v_mfma_f32_16x16x32_bf16 v[52:55], v[232:235], a[156:159], v[52:55]
  ds_read_b64_tr_b16 v[216:217], v117 offset:36864
  ds_read_b64_tr_b16 v[218:219], v117 offset:37888
  v_mfma_f32_16x16x32_bf16 v[68:71], v[232:235], a[160:163], v[68:71]
  ds_read_b64_tr_b16 v[220:221], v118 offset:36864
  ds_read_b64_tr_b16 v[222:223], v118 offset:37888
  v_mfma_f32_16x16x32_bf16 v[84:87], v[232:235], a[164:167], v[84:87]
  ds_read_b64_tr_b16 v[224:225], v119 offset:36864
  ds_read_b64_tr_b16 v[226:227], v119 offset:37888
  v_mfma_f32_16x16x32_bf16 v[100:103], v[232:235], a[168:171], v[100:103]
  s_add_u32 m0, s57, 0x16000
  v_mfma_f32_16x16x32_bf16 v[40:43], v[236:239], a[152:155], v[40:43]
  buffer_load_dwordx4 v18, s[40:43], s48 offen lds
  v_mfma_f32_16x16x32_bf16 v[56:59], v[236:239], a[156:159], v[56:59]
  v_mfma_f32_16x16x32_bf16 v[72:75], v[236:239], a[160:163], v[72:75]
  buffer_load_dwordx4 v19, s[40:43], s49 offen offset:1024 lds
  v_mfma_f32_16x16x32_bf16 v[88:91], v[236:239], a[164:167], v[88:91]
  v_mfma_f32_16x16x32_bf16 v[104:107], v[236:239], a[168:171], v[104:107]
  buffer_load_dwordx4 v18, s[40:43], s50 offen offset:2048 lds
  v_mfma_f32_16x16x32_bf16 v[44:47], v[240:243], a[152:155], v[44:47]
  v_mfma_f32_16x16x32_bf16 v[60:63], v[240:243], a[156:159], v[60:63]
  buffer_load_dwordx4 v19, s[40:43], s51 offen offset:3072 lds
  v_mfma_f32_16x16x32_bf16 v[76:79], v[240:243], a[160:163], v[76:79]
  s_add_u32 m0, s57, 0x17000
  v_mfma_f32_16x16x32_bf16 v[92:95], v[240:243], a[164:167], v[92:95]
  buffer_load_dwordx4 v18, s[40:43], s52 offen lds
  v_mfma_f32_16x16x32_bf16 v[108:111], v[240:243], a[168:171], v[108:111]
  s_waitcnt lgkmcnt(0)
  v_mfma_f32_16x16x32_bf16 v[32:35], v[212:215], a[132:135], v[32:35]
  s_add_u32 s48, s48, 128
  ds_read_b128 a[152:155], v113 offset:36864
  v_mfma_f32_16x16x32_bf16 v[48:51], v[212:215], a[136:139], v[48:51]
  s_add_u32 s49, s49, 128
  ds_read_b64_tr_b16 v[228:229], v116 offset:45056
  ds_read_b64_tr_b16 v[230:231], v116 offset:46080
  v_mfma_f32_16x16x32_bf16 v[64:67], v[212:215], a[140:143], v[64:67]
  s_add_u32 s50, s50, 128
  ds_read_b128 a[156:159], v113 offset:38912
  v_mfma_f32_16x16x32_bf16 v[80:83], v[212:215], a[144:147], v[80:83]
  s_add_u32 s51, s51, 128
  ds_read_b128 a[160:163], v113 offset:40960
  v_mfma_f32_16x16x32_bf16 v[96:99], v[212:215], a[148:151], v[96:99]
  s_add_u32 s52, s52, 128
  ds_read_b128 a[164:167], v113 offset:43008
  v_mfma_f32_16x16x32_bf16 v[36:39], v[216:219], a[132:135], v[36:39]
  ds_read_b128 a[168:171], v113 offset:45056
  v_mfma_f32_16x16x32_bf16 v[52:55], v[216:219], a[136:139], v[52:55]
  ds_read_b64_tr_b16 v[232:233], v117 offset:45056
  ds_read_b64_tr_b16 v[234:235], v117 offset:46080
  v_mfma_f32_16x16x32_bf16 v[68:71], v[216:219], a[140:143], v[68:71]
  ds_read_b64_tr_b16 v[236:237], v118 offset:45056
  ds_read_b64_tr_b16 v[238:239], v118 offset:46080
  v_mfma_f32_16x16x32_bf16 v[84:87], v[216:219], a[144:147], v[84:87]
  ds_read_b64_tr_b16 v[240:241], v119 offset:45056
  ds_read_b64_tr_b16 v[242:243], v119 offset:46080
  v_mfma_f32_16x16x32_bf16 v[100:103], v[216:219], a[148:151], v[100:103]
  s_add_u32 m0, s27, 0x1b000
  v_mfma_f32_16x16x32_bf16 v[40:43], v[220:223], a[132:135], v[40:43]
  buffer_load_dwordx4 v20, s[44:47], s53 offen lds
  v_mfma_f32_16x16x32_bf16 v[56:59], v[220:223], a[136:139], v[56:59]
  v_mfma_f32_16x16x32_bf16 v[72:75], v[220:223], a[140:143], v[72:75]
  buffer_load_dwordx4 v20, s[44:47], s54 offen offset:1024 lds
  v_mfma_f32_16x16x32_bf16 v[88:91], v[220:223], a[144:147], v[88:91]
  s_add_u32 m0, s27, 0x1d000
  v_mfma_f32_16x16x32_bf16 v[104:107], v[220:223], a[148:151], v[104:107]
  buffer_load_dwordx4 v20, s[44:47], s55 offen lds
  v_mfma_f32_16x16x32_bf16 v[44:47], v[224:227], a[132:135], v[44:47]
  v_mfma_f32_16x16x32_bf16 v[60:63], v[224:227], a[136:139], v[60:63]
  buffer_load_dwordx4 v20, s[44:47], s56 offen offset:1024 lds
  v_mfma_f32_16x16x32_bf16 v[76:79], v[224:227], a[140:143], v[76:79]
  v_mfma_f32_16x16x32_bf16 v[92:95], v[224:227], a[144:147], v[92:95]
  v_mfma_f32_16x16x32_bf16 v[108:111], v[224:227], a[148:151], v[108:111]
  s_waitcnt vmcnt(18) lgkmcnt(0)
  s_barrier
  v_mfma_f32_16x16x32_bf16 v[32:35], v[228:231], a[152:155], v[32:35]
  s_add_u32 s53, s53, 0x80000
  ds_read_b128 a[132:135], v21 offset:0
  v_mfma_f32_16x16x32_bf16 v[48:51], v[228:231], a[156:159], v[48:51]
  s_add_u32 s54, s54, 0x80000
  ds_read_b64_tr_b16 v[212:213], v23 offset:0
  ds_read_b64_tr_b16 v[214:215], v23 offset:1024
  v_mfma_f32_16x16x32_bf16 v[64:67], v[228:231], a[160:163], v[64:67]
  s_add_u32 s55, s55, 0x80000
  ds_read_b128 a[136:139], v21 offset:2048
  v_mfma_f32_16x16x32_bf16 v[80:83], v[228:231], a[164:167], v[80:83]
  s_add_u32 s56, s56, 0x80000
  ds_read_b128 a[140:143], v21 offset:4096
  v_mfma_f32_16x16x32_bf16 v[96:99], v[228:231], a[168:171], v[96:99]
  ds_read_b128 a[144:147], v21 offset:6144
  v_mfma_f32_16x16x32_bf16 v[36:39], v[232:235], a[152:155], v[36:39]
  ds_read_b128 a[148:151], v21 offset:8192
  v_mfma_f32_16x16x32_bf16 v[52:55], v[232:235], a[156:159], v[52:55]
  ds_read_b64_tr_b16 v[216:217], v24 offset:0
  ds_read_b64_tr_b16 v[218:219], v24 offset:1024
  v_mfma_f32_16x16x32_bf16 v[68:71], v[232:235], a[160:163], v[68:71]
  ds_read_b64_tr_b16 v[220:221], v25 offset:0
  ds_read_b64_tr_b16 v[222:223], v25 offset:1024
  v_mfma_f32_16x16x32_bf16 v[84:87], v[232:235], a[164:167], v[84:87]
  ds_read_b64_tr_b16 v[224:225], v26 offset:0
  ds_read_b64_tr_b16 v[226:227], v26 offset:1024
  v_mfma_f32_16x16x32_bf16 v[100:103], v[232:235], a[168:171], v[100:103]
  s_add_u32 m0, s57, 0x1f000
  v_mfma_f32_16x16x32_bf16 v[40:43], v[236:239], a[152:155], v[40:43]
  buffer_load_dwordx4 v18, s[40:43], s48 offen lds
  v_mfma_f32_16x16x32_bf16 v[56:59], v[236:239], a[156:159], v[56:59]
  v_mfma_f32_16x16x32_bf16 v[72:75], v[236:239], a[160:163], v[72:75]
  buffer_load_dwordx4 v19, s[40:43], s49 offen offset:1024 lds
  v_mfma_f32_16x16x32_bf16 v[88:91], v[236:239], a[164:167], v[88:91]
  v_mfma_f32_16x16x32_bf16 v[104:107], v[236:239], a[168:171], v[104:107]
  buffer_load_dwordx4 v18, s[40:43], s50 offen offset:2048 lds
  v_mfma_f32_16x16x32_bf16 v[44:47], v[240:243], a[152:155], v[44:47]
  v_mfma_f32_16x16x32_bf16 v[60:63], v[240:243], a[156:159], v[60:63]
  buffer_load_dwordx4 v19, s[40:43], s51 offen offset:3072 lds
  v_mfma_f32_16x16x32_bf16 v[76:79], v[240:243], a[160:163], v[76:79]
  s_add_u32 m0, s57, 0x20000
  v_mfma_f32_16x16x32_bf16 v[92:95], v[240:243], a[164:167], v[92:95]
  buffer_load_dwordx4 v18, s[40:43], s52 offen lds
  v_mfma_f32_16x16x32_bf16 v[108:111], v[240:243], a[168:171], v[108:111]
  s_waitcnt lgkmcnt(0)
  v_mfma_f32_16x16x32_bf16 v[32:35], v[212:215], a[132:135], v[32:35]
  ds_read_b128 a[152:155], v22 offset:0
  v_mfma_f32_16x16x32_bf16 v[48:51], v[212:215], a[136:139], v[48:51]
  ds_read_b64_tr_b16 v[228:229], v23 offset:8192
  ds_read_b64_tr_b16 v[230:231], v23 offset:9216
  v_mfma_f32_16x16x32_bf16 v[64:67], v[212:215], a[140:143], v[64:67]
  ds_read_b128 a[156:159], v22 offset:2048
  v_mfma_f32_16x16x32_bf16 v[80:83], v[212:215], a[144:147], v[80:83]
  ds_read_b128 a[160:163], v22 offset:4096
  v_mfma_f32_16x16x32_bf16 v[96:99], v[212:215], a[148:151], v[96:99]
  ds_read_b128 a[164:167], v22 offset:6144
  v_mfma_f32_16x16x32_bf16 v[36:39], v[216:219], a[132:135], v[36:39]
  ds_read_b128 a[168:171], v22 offset:8192
  v_mfma_f32_16x16x32_bf16 v[52:55], v[216:219], a[136:139], v[52:55]
  ds_read_b64_tr_b16 v[232:233], v24 offset:8192
  ds_read_b64_tr_b16 v[234:235], v24 offset:9216
  v_mfma_f32_16x16x32_bf16 v[68:71], v[216:219], a[140:143], v[68:71]
  ds_read_b64_tr_b16 v[236:237], v25 offset:8192
  ds_read_b64_tr_b16 v[238:239], v25 offset:9216
  v_mfma_f32_16x16x32_bf16 v[84:87], v[216:219], a[144:147], v[84:87]
  ds_read_b64_tr_b16 v[240:241], v26 offset:8192
  ds_read_b64_tr_b16 v[242:243], v26 offset:9216
  v_mfma_f32_16x16x32_bf16 v[100:103], v[216:219], a[148:151], v[100:103]
  s_add_u32 m0, s27, 0x24000
  v_mfma_f32_16x16x32_bf16 v[40:43], v[220:223], a[132:135], v[40:43]
  buffer_load_dwordx4 v20, s[44:47], s53 offen lds
  v_mfma_f32_16x16x32_bf16 v[56:59], v[220:223], a[136:139], v[56:59]
  v_mfma_f32_16x16x32_bf16 v[72:75], v[220:223], a[140:143], v[72:75]
  buffer_load_dwordx4 v20, s[44:47], s54 offen offset:1024 lds
  v_mfma_f32_16x16x32_bf16 v[88:91], v[220:223], a[144:147], v[88:91]
  s_add_u32 m0, s27, 0x26000
  v_mfma_f32_16x16x32_bf16 v[104:107], v[220:223], a[148:151], v[104:107]
  buffer_load_dwordx4 v20, s[44:47], s55 offen lds
  v_mfma_f32_16x16x32_bf16 v[44:47], v[224:227], a[132:135], v[44:47]
  v_mfma_f32_16x16x32_bf16 v[60:63], v[224:227], a[136:139], v[60:63]
  buffer_load_dwordx4 v20, s[44:47], s56 offen offset:1024 lds
  v_mfma_f32_16x16x32_bf16 v[76:79], v[224:227], a[140:143], v[76:79]
  v_mfma_f32_16x16x32_bf16 v[92:95], v[224:227], a[144:147], v[92:95]
  v_mfma_f32_16x16x32_bf16 v[108:111], v[224:227], a[148:151], v[108:111]
  s_waitcnt vmcnt(18) lgkmcnt(0)
  s_barrier
  v_mfma_f32_16x16x32_bf16 v[32:35], v[228:231], a[152:155], v[32:35]
  ds_read_b128 a[132:135], v21 offset:36864
  v_mfma_f32_16x16x32_bf16 v[48:51], v[228:231], a[156:159], v[48:51]
  ds_read_b64_tr_b16 v[212:213], v23 offset:36864
  ds_read_b64_tr_b16 v[214:215], v23 offset:37888
  v_mfma_f32_16x16x32_bf16 v[64:67], v[228:231], a[160:163], v[64:67]
  ds_read_b128 a[136:139], v21 offset:38912
  v_mfma_f32_16x16x32_bf16 v[80:83], v[228:231], a[164:167], v[80:83]
  ds_read_b128 a[140:143], v21 offset:40960
  v_mfma_f32_16x16x32_bf16 v[96:99], v[228:231], a[168:171], v[96:99]
  ds_read_b128 a[144:147], v21 offset:43008
  v_mfma_f32_16x16x32_bf16 v[36:39], v[232:235], a[152:155], v[36:39]
  ds_read_b128 a[148:151], v21 offset:45056
  v_mfma_f32_16x16x32_bf16 v[52:55], v[232:235], a[156:159], v[52:55]
  ds_read_b64_tr_b16 v[216:217], v24 offset:36864
  ds_read_b64_tr_b16 v[218:219], v24 offset:37888
  v_mfma_f32_16x16x32_bf16 v[68:71], v[232:235], a[160:163], v[68:71]
  ds_read_b64_tr_b16 v[220:221], v25 offset:36864
  ds_read_b64_tr_b16 v[222:223], v25 offset:37888
  v_mfma_f32_16x16x32_bf16 v[84:87], v[232:235], a[164:167], v[84:87]
  s_mov_b32 s28, 0x0
  ds_read_b64_tr_b16 v[224:225], v26 offset:36864
  ds_read_b64_tr_b16 v[226:227], v26 offset:37888
  v_mfma_f32_16x16x32_bf16 v[100:103], v[232:235], a[168:171], v[100:103]
  s_add_u32 m0, s27, 0x0
  v_mfma_f32_16x16x32_bf16 v[40:43], v[236:239], a[152:155], v[40:43]
  buffer_load_dwordx4 v1, s[12:15], s28 offen nt lds
  v_mfma_f32_16x16x32_bf16 v[56:59], v[236:239], a[156:159], v[56:59]
  v_mfma_f32_16x16x32_bf16 v[72:75], v[236:239], a[160:163], v[72:75]
  s_mov_b32 s29, 0x2000
  buffer_load_dwordx4 v2, s[12:15], s28 offen offset:1024 nt lds
  v_mfma_f32_16x16x32_bf16 v[88:91], v[236:239], a[164:167], v[88:91]
  s_add_u32 m0, s27, 0x2000
  v_mfma_f32_16x16x32_bf16 v[104:107], v[236:239], a[168:171], v[104:107]
  buffer_load_dwordx4 v1, s[12:15], s29 offen nt lds
  v_mfma_f32_16x16x32_bf16 v[44:47], v[240:243], a[152:155], v[44:47]
  v_mfma_f32_16x16x32_bf16 v[60:63], v[240:243], a[156:159], v[60:63]
  buffer_load_dwordx4 v2, s[12:15], s29 offen offset:1024 nt lds
  v_mfma_f32_16x16x32_bf16 v[76:79], v[240:243], a[160:163], v[76:79]
  v_mfma_f32_16x16x32_bf16 v[92:95], v[240:243], a[164:167], v[92:95]
  v_mfma_f32_16x16x32_bf16 v[108:111], v[240:243], a[168:171], v[108:111]
  s_waitcnt lgkmcnt(0)
  v_mfma_f32_16x16x32_bf16 v[32:35], v[212:215], a[132:135], v[32:35]
  ds_read_b128 a[152:155], v22 offset:36864
  v_mfma_f32_16x16x32_bf16 v[48:51], v[212:215], a[136:139], v[48:51]
  ds_read_b64_tr_b16 v[228:229], v23 offset:45056
  ds_read_b64_tr_b16 v[230:231], v23 offset:46080
  v_mfma_f32_16x16x32_bf16 v[64:67], v[212:215], a[140:143], v[64:67]
  ds_read_b128 a[156:159], v22 offset:38912
  v_mfma_f32_16x16x32_bf16 v[80:83], v[212:215], a[144:147], v[80:83]
  ds_read_b128 a[160:163], v22 offset:40960
  v_mfma_f32_16x16x32_bf16 v[96:99], v[212:215], a[148:151], v[96:99]
  ds_read_b128 a[164:167], v22 offset:43008
  v_mfma_f32_16x16x32_bf16 v[36:39], v[216:219], a[132:135], v[36:39]
  ds_read_b128 a[168:171], v22 offset:45056
  v_mfma_f32_16x16x32_bf16 v[52:55], v[216:219], a[136:139], v[52:55]
  ds_read_b64_tr_b16 v[232:233], v24 offset:45056
  ds_read_b64_tr_b16 v[234:235], v24 offset:46080
  v_mfma_f32_16x16x32_bf16 v[68:71], v[216:219], a[140:143], v[68:71]
  ds_read_b64_tr_b16 v[236:237], v25 offset:45056
  ds_read_b64_tr_b16 v[238:239], v25 offset:46080
  v_mfma_f32_16x16x32_bf16 v[84:87], v[216:219], a[144:147], v[84:87]
  s_mov_b32 s28, 0x4000
  ds_read_b64_tr_b16 v[240:241], v26 offset:45056
  ds_read_b64_tr_b16 v[242:243], v26 offset:46080
  v_mfma_f32_16x16x32_bf16 v[100:103], v[216:219], a[148:151], v[100:103]
  s_add_u32 m0, s27, 0x4000
  v_mfma_f32_16x16x32_bf16 v[40:43], v[220:223], a[132:135], v[40:43]
  buffer_load_dwordx4 v1, s[12:15], s28 offen nt lds
  v_mfma_f32_16x16x32_bf16 v[56:59], v[220:223], a[136:139], v[56:59]
  v_mfma_f32_16x16x32_bf16 v[72:75], v[220:223], a[140:143], v[72:75]
  s_mov_b32 s29, 0x6000
  buffer_load_dwordx4 v2, s[12:15], s28 offen offset:1024 nt lds
  v_mfma_f32_16x16x32_bf16 v[88:91], v[220:223], a[144:147], v[88:91]
  s_add_u32 m0, s27, 0x6000
  v_mfma_f32_16x16x32_bf16 v[104:107], v[220:223], a[148:151], v[104:107]
  buffer_load_dwordx4 v1, s[12:15], s29 offen nt lds
  v_mfma_f32_16x16x32_bf16 v[44:47], v[224:227], a[132:135], v[44:47]
  v_mfma_f32_16x16x32_bf16 v[60:63], v[224:227], a[136:139], v[60:63]
  buffer_load_dwordx4 v2, s[12:15], s29 offen offset:1024 nt lds
  v_mfma_f32_16x16x32_bf16 v[76:79], v[224:227], a[140:143], v[76:79]
  v_mfma_f32_16x16x32_bf16 v[92:95], v[224:227], a[144:147], v[92:95]
  v_mfma_f32_16x16x32_bf16 v[108:111], v[224:227], a[148:151], v[108:111]
  s_waitcnt vmcnt(17) lgkmcnt(0)
  s_barrier
  v_mfma_f32_16x16x32_bf16 v[32:35], v[228:231], a[152:155], v[32:35]
  ds_read_b128 a[132:135], v112 offset:0
  v_mfma_f32_16x16x32_bf16 v[48:51], v[228:231], a[156:159], v[48:51]
  ds_read_b64_tr_b16 v[212:213], v116 offset:0
  ds_read_b64_tr_b16 v[214:215], v116 offset:1024
  v_mfma_f32_16x16x32_bf16 v[64:67], v[228:231], a[160:163], v[64:67]
  ds_read_b128 a[136:139], v112 offset:2048
  v_mfma_f32_16x16x32_bf16 v[80:83], v[228:231], a[164:167], v[80:83]
  ds_read_b128 a[140:143], v112 offset:4096
  v_mfma_f32_16x16x32_bf16 v[96:99], v[228:231], a[168:171], v[96:99]
  ds_read_b128 a[144:147], v112 offset:6144
  v_mfma_f32_16x16x32_bf16 v[36:39], v[232:235], a[152:155], v[36:39]
  ds_read_b128 a[148:151], v112 offset:8192
  v_mfma_f32_16x16x32_bf16 v[52:55], v[232:235], a[156:159], v[52:55]
  ds_read_b64_tr_b16 v[216:217], v117 offset:0
  ds_read_b64_tr_b16 v[218:219], v117 offset:1024
  v_mfma_f32_16x16x32_bf16 v[68:71], v[232:235], a[160:163], v[68:71]
  ds_read_b64_tr_b16 v[220:221], v118 offset:0
  ds_read_b64_tr_b16 v[222:223], v118 offset:1024
  v_mfma_f32_16x16x32_bf16 v[84:87], v[232:235], a[164:167], v[84:87]
  s_mov_b32 s30, 0x0
  ds_read_b64_tr_b16 v[224:225], v119 offset:0
  ds_read_b64_tr_b16 v[226:227], v119 offset:1024
  v_mfma_f32_16x16x32_bf16 v[100:103], v[232:235], a[168:171], v[100:103]
  s_add_u32 m0, s27, 0x10000
  v_mfma_f32_16x16x32_bf16 v[40:43], v[236:239], a[152:155], v[40:43]
  buffer_load_dwordx4 v3, s[16:19], s30 offen nt lds
  v_mfma_f32_16x16x32_bf16 v[56:59], v[236:239], a[156:159], v[56:59]
  v_mfma_f32_16x16x32_bf16 v[72:75], v[236:239], a[160:163], v[72:75]
  s_mov_b32 s31, 0x2000
  buffer_load_dwordx4 v4, s[16:19], s30 offen offset:1024 nt lds
  v_mfma_f32_16x16x32_bf16 v[88:91], v[236:239], a[164:167], v[88:91]
  s_add_u32 m0, s27, 0x12000
  v_mfma_f32_16x16x32_bf16 v[104:107], v[236:239], a[168:171], v[104:107]
  buffer_load_dwordx4 v3, s[16:19], s31 offen nt lds
  v_mfma_f32_16x16x32_bf16 v[44:47], v[240:243], a[152:155], v[44:47]
  v_mfma_f32_16x16x32_bf16 v[60:63], v[240:243], a[156:159], v[60:63]
  buffer_load_dwordx4 v4, s[16:19], s31 offen offset:1024 nt lds
  v_mfma_f32_16x16x32_bf16 v[76:79], v[240:243], a[160:163], v[76:79]
  v_mfma_f32_16x16x32_bf16 v[92:95], v[240:243], a[164:167], v[92:95]
  v_mfma_f32_16x16x32_bf16 v[108:111], v[240:243], a[168:171], v[108:111]
  s_waitcnt lgkmcnt(0)
  v_mfma_f32_16x16x32_bf16 v[32:35], v[212:215], a[132:135], v[32:35]
  ds_read_b128 a[152:155], v113 offset:0
  v_mfma_f32_16x16x32_bf16 v[48:51], v[212:215], a[136:139], v[48:51]
  ds_read_b64_tr_b16 v[228:229], v116 offset:8192
  ds_read_b64_tr_b16 v[230:231], v116 offset:9216
  v_mfma_f32_16x16x32_bf16 v[64:67], v[212:215], a[140:143], v[64:67]
  ds_read_b128 a[156:159], v113 offset:2048
  v_mfma_f32_16x16x32_bf16 v[80:83], v[212:215], a[144:147], v[80:83]
  ds_read_b128 a[160:163], v113 offset:4096
  v_mfma_f32_16x16x32_bf16 v[96:99], v[212:215], a[148:151], v[96:99]
  ds_read_b128 a[164:167], v113 offset:6144
  v_mfma_f32_16x16x32_bf16 v[36:39], v[216:219], a[132:135], v[36:39]
  ds_read_b128 a[168:171], v113 offset:8192
  v_mfma_f32_16x16x32_bf16 v[52:55], v[216:219], a[136:139], v[52:55]
  ds_read_b64_tr_b16 v[232:233], v117 offset:8192
  ds_read_b64_tr_b16 v[234:235], v117 offset:9216
  v_mfma_f32_16x16x32_bf16 v[68:71], v[216:219], a[140:143], v[68:71]
  ds_read_b64_tr_b16 v[236:237], v118 offset:8192
  ds_read_b64_tr_b16 v[238:239], v118 offset:9216
  v_mfma_f32_16x16x32_bf16 v[84:87], v[216:219], a[144:147], v[84:87]
  s_mov_b32 s28, 0x8000
  ds_read_b64_tr_b16 v[240:241], v119 offset:8192
  ds_read_b64_tr_b16 v[242:243], v119 offset:9216
  v_mfma_f32_16x16x32_bf16 v[100:103], v[216:219], a[148:151], v[100:103]
  s_add_u32 m0, s27, 0x8000
  v_mfma_f32_16x16x32_bf16 v[40:43], v[220:223], a[132:135], v[40:43]
  buffer_load_dwordx4 v1, s[12:15], s28 offen nt lds
  v_mfma_f32_16x16x32_bf16 v[56:59], v[220:223], a[136:139], v[56:59]
  v_mfma_f32_16x16x32_bf16 v[72:75], v[220:223], a[140:143], v[72:75]
  s_mov_b32 s29, 0xa000
  buffer_load_dwordx4 v2, s[12:15], s28 offen offset:1024 nt lds
  v_mfma_f32_16x16x32_bf16 v[88:91], v[220:223], a[144:147], v[88:91]
  s_add_u32 m0, s27, 0xa000
  v_mfma_f32_16x16x32_bf16 v[104:107], v[220:223], a[148:151], v[104:107]
  buffer_load_dwordx4 v1, s[12:15], s29 offen nt lds
  v_mfma_f32_16x16x32_bf16 v[44:47], v[224:227], a[132:135], v[44:47]
  v_mfma_f32_16x16x32_bf16 v[60:63], v[224:227], a[136:139], v[60:63]
  buffer_load_dwordx4 v2, s[12:15], s29 offen offset:1024 nt lds
  v_mfma_f32_16x16x32_bf16 v[76:79], v[224:227], a[140:143], v[76:79]
  v_mfma_f32_16x16x32_bf16 v[92:95], v[224:227], a[144:147], v[92:95]
  v_mfma_f32_16x16x32_bf16 v[108:111], v[224:227], a[148:151], v[108:111]
  s_waitcnt vmcnt(16) lgkmcnt(0)
  s_barrier
  v_mfma_f32_16x16x32_bf16 v[32:35], v[228:231], a[152:155], v[32:35]
  ds_read_b128 a[132:135], v112 offset:36864
  v_mfma_f32_16x16x32_bf16 v[48:51], v[228:231], a[156:159], v[48:51]
  ds_read_b64_tr_b16 v[212:213], v116 offset:36864
  ds_read_b64_tr_b16 v[214:215], v116 offset:37888
  v_mfma_f32_16x16x32_bf16 v[64:67], v[228:231], a[160:163], v[64:67]
  ds_read_b128 a[136:139], v112 offset:38912
  v_mfma_f32_16x16x32_bf16 v[80:83], v[228:231], a[164:167], v[80:83]
  ds_read_b128 a[140:143], v112 offset:40960
  v_mfma_f32_16x16x32_bf16 v[96:99], v[228:231], a[168:171], v[96:99]
  ds_read_b128 a[144:147], v112 offset:43008
  v_mfma_f32_16x16x32_bf16 v[36:39], v[232:235], a[152:155], v[36:39]
  ds_read_b128 a[148:151], v112 offset:45056
  v_mfma_f32_16x16x32_bf16 v[52:55], v[232:235], a[156:159], v[52:55]
  ds_read_b64_tr_b16 v[216:217], v117 offset:36864
  ds_read_b64_tr_b16 v[218:219], v117 offset:37888
  v_mfma_f32_16x16x32_bf16 v[68:71], v[232:235], a[160:163], v[68:71]
  ds_read_b64_tr_b16 v[220:221], v118 offset:36864
  ds_read_b64_tr_b16 v[222:223], v118 offset:37888
  v_mfma_f32_16x16x32_bf16 v[84:87], v[232:235], a[164:167], v[84:87]
  s_mov_b32 s28, 0xc000
  ds_read_b64_tr_b16 v[224:225], v119 offset:36864
  ds_read_b64_tr_b16 v[226:227], v119 offset:37888
  v_mfma_f32_16x16x32_bf16 v[100:103], v[232:235], a[168:171], v[100:103]
  s_add_u32 m0, s27, 0xc000
  v_mfma_f32_16x16x32_bf16 v[40:43], v[236:239], a[152:155], v[40:43]
  buffer_load_dwordx4 v1, s[12:15], s28 offen nt lds
  v_mfma_f32_16x16x32_bf16 v[56:59], v[236:239], a[156:159], v[56:59]
  v_mfma_f32_16x16x32_bf16 v[72:75], v[236:239], a[160:163], v[72:75]
  s_mov_b32 s29, 0xe000
  buffer_load_dwordx4 v2, s[12:15], s28 offen offset:1024 nt lds
  v_mfma_f32_16x16x32_bf16 v[88:91], v[236:239], a[164:167], v[88:91]
  s_add_u32 m0, s27, 0xe000
  v_mfma_f32_16x16x32_bf16 v[104:107], v[236:239], a[168:171], v[104:107]
  buffer_load_dwordx4 v1, s[12:15], s29 offen nt lds
  v_mfma_f32_16x16x32_bf16 v[44:47], v[240:243], a[152:155], v[44:47]
  v_mfma_f32_16x16x32_bf16 v[60:63], v[240:243], a[156:159], v[60:63]
  buffer_load_dwordx4 v2, s[12:15], s29 offen offset:1024 nt lds
  v_mfma_f32_16x16x32_bf16 v[76:79], v[240:243], a[160:163], v[76:79]
  v_mfma_f32_16x16x32_bf16 v[92:95], v[240:243], a[164:167], v[92:95]
  v_mfma_f32_16x16x32_bf16 v[108:111], v[240:243], a[168:171], v[108:111]
  s_waitcnt lgkmcnt(0)
  v_mfma_f32_16x16x32_bf16 v[32:35], v[212:215], a[132:135], v[32:35]
  ds_read_b128 a[152:155], v113 offset:36864
  v_mfma_f32_16x16x32_bf16 v[48:51], v[212:215], a[136:139], v[48:51]
  ds_read_b64_tr_b16 v[228:229], v116 offset:45056
  ds_read_b64_tr_b16 v[230:231], v116 offset:46080
  v_mfma_f32_16x16x32_bf16 v[64:67], v[212:215], a[140:143], v[64:67]
  ds_read_b128 a[156:159], v113 offset:38912
  v_mfma_f32_16x16x32_bf16 v[80:83], v[212:215], a[144:147], v[80:83]
  ds_read_b128 a[160:163], v113 offset:40960
  v_mfma_f32_16x16x32_bf16 v[96:99], v[212:215], a[148:151], v[96:99]
  ds_read_b128 a[164:167], v113 offset:43008
  v_mfma_f32_16x16x32_bf16 v[36:39], v[216:219], a[132:135], v[36:39]
  ds_read_b128 a[168:171], v113 offset:45056
  v_mfma_f32_16x16x32_bf16 v[52:55], v[216:219], a[136:139], v[52:55]
  ds_read_b64_tr_b16 v[232:233], v117 offset:45056
  ds_read_b64_tr_b16 v[234:235], v117 offset:46080
  v_mfma_f32_16x16x32_bf16 v[68:71], v[216:219], a[140:143], v[68:71]
  ds_read_b64_tr_b16 v[236:237], v118 offset:45056
  ds_read_b64_tr_b16 v[238:239], v118 offset:46080
  v_mfma_f32_16x16x32_bf16 v[84:87], v[216:219], a[144:147], v[84:87]
  s_mov_b32 s30, 0x4000
  ds_read_b64_tr_b16 v[240:241], v119 offset:45056
  ds_read_b64_tr_b16 v[242:243], v119 offset:46080
  v_mfma_f32_16x16x32_bf16 v[100:103], v[216:219], a[148:151], v[100:103]
  s_add_u32 m0, s27, 0x14000
  v_mfma_f32_16x16x32_bf16 v[40:43], v[220:223], a[132:135], v[40:43]
  buffer_load_dwordx4 v3, s[16:19], s30 offen nt lds
  v_mfma_f32_16x16x32_bf16 v[56:59], v[220:223], a[136:139], v[56:59]
  v_mfma_f32_16x16x32_bf16 v[72:75], v[220:223], a[140:143], v[72:75]
  s_mov_b32 s31, 0x6000
  buffer_load_dwordx4 v4, s[16:19], s30 offen offset:1024 nt lds
  v_mfma_f32_16x16x32_bf16 v[88:91], v[220:223], a[144:147], v[88:91]
  s_add_u32 m0, s27, 0x16000
  v_mfma_f32_16x16x32_bf16 v[104:107], v[220:223], a[148:151], v[104:107]
  buffer_load_dwordx4 v3, s[16:19], s31 offen nt lds
  v_mfma_f32_16x16x32_bf16 v[44:47], v[224:227], a[132:135], v[44:47]
  v_mfma_f32_16x16x32_bf16 v[60:63], v[224:227], a[136:139], v[60:63]
  buffer_load_dwordx4 v4, s[16:19], s31 offen offset:1024 nt lds
  v_mfma_f32_16x16x32_bf16 v[76:79], v[224:227], a[140:143], v[76:79]
  v_mfma_f32_16x16x32_bf16 v[92:95], v[224:227], a[144:147], v[92:95]
  v_mfma_f32_16x16x32_bf16 v[108:111], v[224:227], a[148:151], v[108:111]
  s_waitcnt lgkmcnt(0)
  s_barrier
  v_mfma_f32_16x16x32_bf16 v[32:35], v[228:231], a[152:155], v[32:35]
  v_mov_b64 v[112:113], 0
  v_mov_b64 v[114:115], 0
  v_mov_b64 v[116:117], 0
  v_mfma_f32_16x16x32_bf16 v[48:51], v[228:231], a[156:159], v[48:51]
  v_mov_b64 v[118:119], 0
  v_mov_b64 v[120:121], 0
  v_mov_b64 v[122:123], 0
  v_mfma_f32_16x16x32_bf16 v[64:67], v[228:231], a[160:163], v[64:67]
  v_mov_b64 v[124:125], 0
  v_mov_b64 v[126:127], 0
  v_mov_b64 v[128:129], 0
  v_mfma_f32_16x16x32_bf16 v[80:83], v[228:231], a[164:167], v[80:83]
  s_mov_b32 s30, 0x8000
  v_mov_b64 v[130:131], 0
  v_mfma_f32_16x16x32_bf16 v[96:99], v[228:231], a[168:171], v[96:99]
  s_add_u32 m0, s27, 0x18000
  v_pk_mul_f32 v[32:33], v[32:33], s[60:61]
  v_pk_mul_f32 v[34:35], v[34:35], s[60:61]
  v_mfma_f32_16x16x32_bf16 v[36:39], v[232:235], a[152:155], v[36:39]
  buffer_load_dwordx4 v3, s[16:19], s30 offen nt lds
  v_cvt_pk_bf16_f32 v32, v32, v33
  v_cvt_pk_bf16_f32 v33, v34, v35
  v_mfma_f32_16x16x32_bf16 v[52:55], v[232:235], a[156:159], v[52:55]
  ds_write_b64 v27, v[32:33] offset:0
  v_pk_mul_f32 v[48:49], v[48:49], s[60:61]
  v_pk_mul_f32 v[50:51], v[50:51], s[60:61]
  v_mfma_f32_16x16x32_bf16 v[68:71], v[232:235], a[160:163], v[68:71]
  v_cvt_pk_bf16_f32 v48, v48, v49
  v_cvt_pk_bf16_f32 v49, v50, v51
  v_pk_mul_f32 v[64:65], v[64:65], s[60:61]
  v_mfma_f32_16x16x32_bf16 v[84:87], v[232:235], a[164:167], v[84:87]
  ds_write_b64 v27, v[48:49] offset:4096
  v_pk_mul_f32 v[66:67], v[66:67], s[60:61]
  v_pk_mul_f32 v[80:81], v[80:81], s[60:61]
  v_mfma_f32_16x16x32_bf16 v[100:103], v[232:235], a[168:171], v[100:103]
  buffer_load_dwordx4 v4, s[16:19], s30 offen offset:1024 nt lds
  v_cvt_pk_bf16_f32 v64, v64, v65
  v_cvt_pk_bf16_f32 v65, v66, v67
  v_mfma_f32_16x16x32_bf16 v[40:43], v[236:239], a[152:155], v[40:43]
  ds_write_b64 v27, v[64:65] offset:8192
  v_pk_mul_f32 v[82:83], v[82:83], s[60:61]
  v_pk_mul_f32 v[96:97], v[96:97], s[60:61]
  v_mfma_f32_16x16x32_bf16 v[56:59], v[236:239], a[156:159], v[56:59]
  s_mov_b32 s31, 0xa000
  v_cvt_pk_bf16_f32 v80, v80, v81
  v_cvt_pk_bf16_f32 v81, v82, v83
  v_pk_mul_f32 v[98:99], v[98:99], s[60:61]
  v_mfma_f32_16x16x32_bf16 v[72:75], v[236:239], a[160:163], v[72:75]
  s_add_u32 m0, s27, 0x1a000
  ds_write_b64 v27, v[80:81] offset:12288
  v_cvt_pk_bf16_f32 v96, v96, v97
  v_cvt_pk_bf16_f32 v97, v98, v99
  v_mfma_f32_16x16x32_bf16 v[88:91], v[236:239], a[164:167], v[88:91]
  buffer_load_dwordx4 v3, s[16:19], s31 offen nt lds
  ds_write_b64 v27, v[96:97] offset:16384
  v_pk_mul_f32 v[36:37], v[36:37], s[60:61]
  v_mfma_f32_16x16x32_bf16 v[104:107], v[236:239], a[168:171], v[104:107]
  v_pk_mul_f32 v[38:39], v[38:39], s[60:61]
  v_pk_mul_f32 v[52:53], v[52:53], s[60:61]
  v_pk_mul_f32 v[54:55], v[54:55], s[60:61]
  v_mfma_f32_16x16x32_bf16 v[44:47], v[240:243], a[152:155], v[44:47]
  v_cvt_pk_bf16_f32 v36, v36, v37
  v_cvt_pk_bf16_f32 v37, v38, v39
  v_cvt_pk_bf16_f32 v52, v52, v53
  v_mfma_f32_16x16x32_bf16 v[60:63], v[240:243], a[156:159], v[60:63]
  ds_write_b64 v27, v[36:37] offset:512
  v_cvt_pk_bf16_f32 v53, v54, v55
  v_pk_mul_f32 v[68:69], v[68:69], s[60:61]
  v_mfma_f32_16x16x32_bf16 v[76:79], v[240:243], a[160:163], v[76:79]
  buffer_load_dwordx4 v4, s[16:19], s31 offen offset:1024 nt lds
  ds_write_b64 v27, v[52:53] offset:4608
  v_pk_mul_f32 v[70:71], v[70:71], s[60:61]
  v_mfma_f32_16x16x32_bf16 v[92:95], v[240:243], a[164:167], v[92:95]
  v_cvt_pk_bf16_f32 v68, v68, v69
  v_cvt_pk_bf16_f32 v69, v70, v71
  v_pk_mul_f32 v[84:85], v[84:85], s[60:61]
  v_mfma_f32_16x16x32_bf16 v[108:111], v[240:243], a[168:171], v[108:111]
  ds_write_b64 v27, v[68:69] offset:8704
  v_pk_mul_f32 v[86:87], v[86:87], s[60:61]
  v_pk_mul_f32 v[100:101], v[100:101], s[60:61]
  s_nop 3
  v_pk_mul_f32 v[102:103], v[102:103], s[60:61]
  v_pk_mul_f32 v[40:41], v[40:41], s[60:61]
  v_pk_mul_f32 v[42:43], v[42:43], s[60:61]
  v_pk_mul_f32 v[56:57], v[56:57], s[60:61]
  v_pk_mul_f32 v[58:59], v[58:59], s[60:61]
  v_pk_mul_f32 v[72:73], v[72:73], s[60:61]
  v_pk_mul_f32 v[74:75], v[74:75], s[60:61]
  v_pk_mul_f32 v[88:89], v[88:89], s[60:61]
  v_pk_mul_f32 v[90:91], v[90:91], s[60:61]
  v_pk_mul_f32 v[104:105], v[104:105], s[60:61]
  v_pk_mul_f32 v[106:107], v[106:107], s[60:61]
  v_pk_mul_f32 v[44:45], v[44:45], s[60:61]
  v_pk_mul_f32 v[46:47], v[46:47], s[60:61]
  v_pk_mul_f32 v[60:61], v[60:61], s[60:61]
  v_pk_mul_f32 v[62:63], v[62:63], s[60:61]
  v_pk_mul_f32 v[76:77], v[76:77], s[60:61]
  v_pk_mul_f32 v[78:79], v[78:79], s[60:61]
  v_pk_mul_f32 v[92:93], v[92:93], s[60:61]
  v_pk_mul_f32 v[94:95], v[94:95], s[60:61]
  v_pk_mul_f32 v[108:109], v[108:109], s[60:61]
  v_pk_mul_f32 v[110:111], v[110:111], s[60:61]
  v_cvt_pk_bf16_f32 v84, v84, v85
  v_cvt_pk_bf16_f32 v85, v86, v87
  v_cvt_pk_bf16_f32 v100, v100, v101
  v_cvt_pk_bf16_f32 v101, v102, v103
  v_cvt_pk_bf16_f32 v40, v40, v41
  v_cvt_pk_bf16_f32 v41, v42, v43
  v_cvt_pk_bf16_f32 v56, v56, v57
  v_cvt_pk_bf16_f32 v57, v58, v59
  v_cvt_pk_bf16_f32 v72, v72, v73
  v_cvt_pk_bf16_f32 v73, v74, v75
  v_cvt_pk_bf16_f32 v88, v88, v89
  v_cvt_pk_bf16_f32 v89, v90, v91
  v_cvt_pk_bf16_f32 v104, v104, v105
  v_cvt_pk_bf16_f32 v105, v106, v107
  v_cvt_pk_bf16_f32 v44, v44, v45
  v_cvt_pk_bf16_f32 v45, v46, v47
  v_cvt_pk_bf16_f32 v60, v60, v61
  v_cvt_pk_bf16_f32 v61, v62, v63
  v_cvt_pk_bf16_f32 v76, v76, v77
  v_cvt_pk_bf16_f32 v77, v78, v79
  v_cvt_pk_bf16_f32 v92, v92, v93
  v_cvt_pk_bf16_f32 v93, v94, v95
  v_cvt_pk_bf16_f32 v108, v108, v109
  v_cvt_pk_bf16_f32 v109, v110, v111
  ds_write_b64 v27, v[84:85] offset:12800
  ds_write_b64 v27, v[100:101] offset:16896
  ds_write_b64 v27, v[40:41] offset:1024
  ds_write_b64 v27, v[56:57] offset:5120
  ds_write_b64 v27, v[72:73] offset:9216
  ds_write_b64 v27, v[88:89] offset:13312
  ds_write_b64 v27, v[104:105] offset:17408
  ds_write_b64 v27, v[44:45] offset:1536
  ds_write_b64 v27, v[60:61] offset:5632
  ds_write_b64 v27, v[76:77] offset:9728
  ds_write_b64 v27, v[92:93] offset:13824
  ds_write_b64 v27, v[108:109] offset:17920
  s_waitcnt vmcnt(20) lgkmcnt(0)
  s_barrier
  s_cmp_lg_u32 s58, 0
  s_cbranch_scc1 L_fb_max
L_qk0:
  s_mul_i32 s35, s25, 20480
  s_add_u32 s35, s35, 0x1e000
  v_add_u32 v248, s35, v30
  ds_read_b128 v[212:215], v5 offset:0
  ds_read_b128 a[132:135], v248 offset:0
  ds_read_b128 a[148:151], v248 offset:4096
  ds_read_b128 a[164:167], v248 offset:8192
  ds_read_b128 a[180:183], v248 offset:12288
  ds_read_b128 a[196:199], v248 offset:16384
  ds_read_b128 v[216:219], v6 offset:0
  ds_read_b128 a[136:139], v248 offset:1024
  ds_read_b128 a[152:155], v248 offset:5120
  ds_read_b128 a[168:171], v248 offset:9216
  ds_read_b128 a[184:187], v248 offset:13312
  ds_read_b128 a[200:203], v248 offset:17408
  s_waitcnt lgkmcnt(6)
  v_mfma_f32_16x16x32_bf16 v[32:35], v[212:215], a[132:135], v[112:115]
  ds_read_b128 v[220:223], v7 offset:0
  ds_read_b128 a[140:143], v248 offset:2048
  v_mfma_f32_16x16x32_bf16 v[40:43], v[212:215], a[148:151], v[116:119]
  ds_read_b128 a[156:159], v248 offset:6144
  v_mfma_f32_16x16x32_bf16 v[48:51], v[212:215], a[164:167], v[120:123]
  ds_read_b128 a[172:175], v248 offset:10240
  v_mfma_f32_16x16x32_bf16 v[56:59], v[212:215], a[180:183], v[124:127]
  ds_read_b128 a[188:191], v248 offset:14336
  v_mfma_f32_16x16x32_bf16 v[64:67], v[212:215], a[196:199], v[128:131]
  s_waitcnt lgkmcnt(5)
  ds_read_b128 a[204:207], v248 offset:18432
  v_mfma_f32_16x16x32_bf16 v[32:35], v[216:219], a[136:139], v[32:35]
  ds_read_b128 v[224:227], v8 offset:0
  ds_read_b128 a[144:147], v248 offset:3072
  v_mfma_f32_16x16x32_bf16 v[40:43], v[216:219], a[152:155], v[40:43]
  ds_read_b128 a[160:163], v248 offset:7168
  v_mfma_f32_16x16x32_bf16 v[48:51], v[216:219], a[168:171], v[48:51]
  ds_read_b128 a[176:179], v248 offset:11264
  v_mfma_f32_16x16x32_bf16 v[56:59], v[216:219], a[184:187], v[56:59]
  ds_read_b128 a[192:195], v248 offset:15360
  v_mfma_f32_16x16x32_bf16 v[64:67], v[216:219], a[200:203], v[64:67]
  s_waitcnt lgkmcnt(5)
  ds_read_b128 a[208:211], v248 offset:19456
  v_mfma_f32_16x16x32_bf16 v[32:35], v[220:223], a[140:143], v[32:35]
  ds_read_b128 v[228:231], v5 offset:4096
  v_mfma_f32_16x16x32_bf16 v[40:43], v[220:223], a[156:159], v[40:43]
  ds_read_b128 v[232:235], v6 offset:4096
  v_mfma_f32_16x16x32_bf16 v[48:51], v[220:223], a[172:175], v[48:51]
  ds_read_b128 v[236:239], v7 offset:4096
  v_mfma_f32_16x16x32_bf16 v[56:59], v[220:223], a[188:191], v[56:59]
  ds_read_b128 v[240:243], v8 offset:4096
  v_mfma_f32_16x16x32_bf16 v[64:67], v[220:223], a[204:207], v[64:67]
  s_waitcnt lgkmcnt(4)
  v_mfma_f32_16x16x32_bf16 v[32:35], v[224:227], a[144:147], v[32:35]
  v_mfma_f32_16x16x32_bf16 v[40:43], v[224:227], a[160:163], v[40:43]
  v_mfma_f32_16x16x32_bf16 v[48:51], v[224:227], a[176:179], v[48:51]
  v_mfma_f32_16x16x32_bf16 v[56:59], v[224:227], a[192:195], v[56:59]
  v_mfma_f32_16x16x32_bf16 v[64:67], v[224:227], a[208:211], v[64:67]
  s_waitcnt lgkmcnt(0)
  s_barrier
  v_mfma_f32_16x16x32_bf16 v[36:39], v[228:231], a[132:135], v[112:115]
  s_mov_b32 s28, 0x10000
  s_add_u32 m0, s27, 0x0
  ds_read_b128 v[212:215], v5 offset:16384
  v_mfma_f32_16x16x32_bf16 v[44:47], v[228:231], a[148:151], v[116:119]
  buffer_load_dwordx4 v1, s[12:15], s28 offen nt lds
  v_mfma_f32_16x16x32_bf16 v[52:55], v[228:231], a[164:167], v[120:123]
  ds_read_b128 v[216:219], v6 offset:16384
  v_mfma_f32_16x16x32_bf16 v[60:63], v[228:231], a[180:183], v[124:127]
  buffer_load_dwordx4 v2, s[12:15], s28 offen offset:1024 nt lds
  v_mfma_f32_16x16x32_bf16 v[68:71], v[228:231], a[196:199], v[128:131]
  s_mov_b32 s29, 0x12000
  s_add_u32 m0, s27, 0x2000
  v_exp_f32 v32, v32
  ds_read_b128 v[220:223], v7 offset:16384
  v_mfma_f32_16x16x32_bf16 v[36:39], v[232:235], a[136:139], v[36:39]
  buffer_load_dwordx4 v1, s[12:15], s29 offen nt lds
  v_exp_f32 v33, v33
  v_mfma_f32_16x16x32_bf16 v[44:47], v[232:235], a[152:155], v[44:47]
  v_exp_f32 v34, v34
  ds_read_b128 v[224:227], v8 offset:16384
  v_mfma_f32_16x16x32_bf16 v[52:55], v[232:235], a[168:171], v[52:55]
  buffer_load_dwordx4 v2, s[12:15], s29 offen offset:1024 nt lds
  v_exp_f32 v35, v35
  v_mfma_f32_16x16x32_bf16 v[60:63], v[232:235], a[184:187], v[60:63]
  v_exp_f32 v40, v40
  ds_read_b128 v[228:231], v5 offset:20480
  v_mfma_f32_16x16x32_bf16 v[68:71], v[232:235], a[200:203], v[68:71]
  v_exp_f32 v41, v41
  v_mfma_f32_16x16x32_bf16 v[36:39], v[236:239], a[140:143], v[36:39]
  v_exp_f32 v42, v42
  ds_read_b128 v[232:235], v6 offset:20480
  v_mfma_f32_16x16x32_bf16 v[44:47], v[236:239], a[156:159], v[44:47]
  v_exp_f32 v43, v43
  v_mfma_f32_16x16x32_bf16 v[52:55], v[236:239], a[172:175], v[52:55]
  v_exp_f32 v48, v48
  v_mfma_f32_16x16x32_bf16 v[60:63], v[236:239], a[188:191], v[60:63]
  v_exp_f32 v49, v49
  v_mfma_f32_16x16x32_bf16 v[68:71], v[236:239], a[204:207], v[68:71]
  v_exp_f32 v50, v50
  v_mfma_f32_16x16x32_bf16 v[36:39], v[240:243], a[144:147], v[36:39]
  v_exp_f32 v51, v51
  v_mfma_f32_16x16x32_bf16 v[44:47], v[240:243], a[160:163], v[44:47]
  v_exp_f32 v56, v56
  ds_read_b128 v[236:239], v7 offset:20480
  v_mfma_f32_16x16x32_bf16 v[52:55], v[240:243], a[176:179], v[52:55]
  v_exp_f32 v57, v57
  v_mfma_f32_16x16x32_bf16 v[60:63], v[240:243], a[192:195], v[60:63]
  v_exp_f32 v58, v58
  v_mfma_f32_16x16x32_bf16 v[68:71], v[240:243], a[208:211], v[68:71]
  v_exp_f32 v59, v59
  ds_read_b128 v[240:243], v8 offset:20480
  s_getpc_b64 s[10:11]
L_ct_sp:
  s_add_u32 s10, s10, 18228
  s_addc_u32 s11, s11, 0
  v_and_b32 v250, 7, v0
  v_lshlrev_b32 v250, 7, v250
  v_mov_b32 v251, s11
  v_add_co_u32 v250, vcc, s10, v250
  v_addc_co_u32 v251, vcc, 0, v251, vcc
  s_mov_b64 exec, 0xff
  global_load_dword a255, v[250:251], off
  s_mov_b64 exec, -1
  v_exp_f32 v64, v64
  v_exp_f32 v65, v65
  v_exp_f32 v66, v66
  v_exp_f32 v67, v67
  v_cvt_pk_bf16_f32 v32, v32, v33
  v_cvt_pk_bf16_f32 v33, v34, v35
  v_cvt_pk_bf16_f32 v40, v40, v41
  v_cvt_pk_bf16_f32 v41, v42, v43
  v_cvt_pk_bf16_f32 v48, v48, v49
  v_cvt_pk_bf16_f32 v49, v50, v51
  v_cvt_pk_bf16_f32 v56, v56, v57
  v_cvt_pk_bf16_f32 v57, v58, v59
  v_cvt_pk_bf16_f32 v64, v64, v65
  v_cvt_pk_bf16_f32 v65, v66, v67
  s_mov_b32 s28, 0x14000
  s_mov_b32 s29, 0x16000
  s_mov_b32 s30, 0xc000
  s_mov_b32 s31, 0xe000
  s_mov_b32 s32, 7
.p2align 6
L_loop:
  s_waitcnt vmcnt(16) lgkmcnt(0)
  s_barrier
  v_mfma_f32_16x16x32_bf16 v[72:75], v[212:215], a[132:135], v[112:115]
  v_exp_f32 v36, v36
  v_mfma_f32_16x16x32_bf16 v[80:83], v[212:215], a[148:151], v[116:119]
  ds_read_b64_tr_b16 a[100:101], v9 offset:0
  ds_read_b64_tr_b16 a[102:103], v9 offset:4096
  v_mfma_f32_16x16x32_bf16 v[88:91], v[212:215], a[164:167], v[120:123]
  s_cmp_lt_u32 s28, 0x80000
  v_exp_f32 v37, v37
  v_mfma_f32_16x16x32_bf16 v[96:99], v[212:215], a[180:183], v[124:127]
  s_cselect_b32 s14, 0x80000, 0
  ds_read_b64_tr_b16 a[104:105], v10 offset:0
  v_cvt_pk_bf16_f32 v34, v36, v37
  v_mfma_f32_16x16x32_bf16 v[104:107], v[212:215], a[196:199], v[128:131]
  s_cmp_lt_u32 s30, 0x80000
  v_exp_f32 v38, v38
  v_mfma_f32_16x16x32_bf16 v[72:75], v[216:219], a[136:139], v[72:75]
  s_cselect_b32 s18, 0x80000, 0
  ds_read_b64_tr_b16 a[106:107], v10 offset:4096
  ds_read_b64_tr_b16 a[108:109], v11 offset:0
  v_mfma_f32_16x16x32_bf16 v[80:83], v[216:219], a[152:155], v[80:83]
  v_exp_f32 v39, v39
  v_mfma_f32_16x16x32_bf16 v[88:91], v[216:219], a[168:171], v[88:91]
  ds_read_b64_tr_b16 a[110:111], v11 offset:4096
  v_cvt_pk_bf16_f32 v35, v38, v39
  v_mfma_f32_16x16x32_bf16 v[96:99], v[216:219], a[184:187], v[96:99]
  v_exp_f32 v44, v44
  v_mfma_f32_16x16x32_bf16 v[104:107], v[216:219], a[200:203], v[104:107]
  ds_read_b64_tr_b16 a[112:113], v12 offset:0
  ds_read_b64_tr_b16 a[114:115], v12 offset:4096
  v_mfma_f32_16x16x32_bf16 v[72:75], v[220:223], a[140:143], v[72:75]
  v_exp_f32 v45, v45
  v_mfma_f32_16x16x32_bf16 v[80:83], v[220:223], a[156:159], v[80:83]
  ds_read_b64_tr_b16 a[116:117], v13 offset:0
  v_cvt_pk_bf16_f32 v42, v44, v45
  v_mfma_f32_16x16x32_bf16 v[88:91], v[220:223], a[172:175], v[88:91]
  v_exp_f32 v46, v46
  v_mfma_f32_16x16x32_bf16 v[96:99], v[220:223], a[188:191], v[96:99]
  ds_read_b64_tr_b16 a[118:119], v13 offset:4096
  ds_read_b64_tr_b16 a[120:121], v14 offset:0
  v_mfma_f32_16x16x32_bf16 v[104:107], v[220:223], a[204:207], v[104:107]
  v_exp_f32 v47, v47
  v_mfma_f32_16x16x32_bf16 v[72:75], v[224:227], a[144:147], v[72:75]
  ds_read_b64_tr_b16 a[122:123], v14 offset:4096
  v_cvt_pk_bf16_f32 v43, v46, v47
  v_mfma_f32_16x16x32_bf16 v[80:83], v[224:227], a[160:163], v[80:83]
  v_exp_f32 v52, v52
  v_mfma_f32_16x16x32_bf16 v[88:91], v[224:227], a[176:179], v[88:91]
  ds_read_b64_tr_b16 a[124:125], v15 offset:0
  ds_read_b64_tr_b16 a[126:127], v15 offset:4096
  v_mfma_f32_16x16x32_bf16 v[96:99], v[224:227], a[192:195], v[96:99]
  v_exp_f32 v53, v53
  v_mfma_f32_16x16x32_bf16 v[104:107], v[224:227], a[208:211], v[104:107]
  ds_read_b64_tr_b16 a[128:129], v16 offset:0
  v_cvt_pk_bf16_f32 v50, v52, v53
  v_mfma_f32_16x16x32_bf16 v[76:79], v[228:231], a[132:135], v[112:115]
  v_exp_f32 v54, v54
  v_mfma_f32_16x16x32_bf16 v[84:87], v[228:231], a[148:151], v[116:119]
  ds_read_b64_tr_b16 a[130:131], v16 offset:4096
  v_mfma_f32_16x16x32_bf16 v[92:95], v[228:231], a[164:167], v[120:123]
  v_exp_f32 v55, v55
  v_mfma_f32_16x16x32_bf16 v[100:103], v[228:231], a[180:183], v[124:127]
  v_cvt_pk_bf16_f32 v51, v54, v55
  v_mfma_f32_16x16x32_bf16 v[108:111], v[228:231], a[196:199], v[128:131]
  s_add_u32 m0, s27, 0x4000
  v_exp_f32 v60, v60
  v_mfma_f32_16x16x32_bf16 v[76:79], v[232:235], a[136:139], v[76:79]
  buffer_load_dwordx4 v1, s[12:15], s28 offen nt lds
  v_mfma_f32_16x16x32_bf16 v[84:87], v[232:235], a[152:155], v[84:87]
  v_exp_f32 v61, v61
  v_mfma_f32_16x16x32_bf16 v[92:95], v[232:235], a[168:171], v[92:95]
  v_cvt_pk_bf16_f32 v58, v60, v61
  v_mfma_f32_16x16x32_bf16 v[100:103], v[232:235], a[184:187], v[100:103]
  v_exp_f32 v62, v62
  v_mfma_f32_16x16x32_bf16 v[108:111], v[232:235], a[200:203], v[108:111]
  buffer_load_dwordx4 v2, s[12:15], s28 offen offset:1024 nt lds
  v_mfma_f32_16x16x32_bf16 v[76:79], v[236:239], a[140:143], v[76:79]
  v_exp_f32 v63, v63
  v_mfma_f32_16x16x32_bf16 v[84:87], v[236:239], a[156:159], v[84:87]
  v_cvt_pk_bf16_f32 v59, v62, v63
  v_mfma_f32_16x16x32_bf16 v[92:95], v[236:239], a[172:175], v[92:95]
  s_add_u32 m0, s27, 0x6000
  v_exp_f32 v68, v68
  v_mfma_f32_16x16x32_bf16 v[100:103], v[236:239], a[188:191], v[100:103]
  buffer_load_dwordx4 v1, s[12:15], s29 offen nt lds
  v_mfma_f32_16x16x32_bf16 v[108:111], v[236:239], a[204:207], v[108:111]
  v_exp_f32 v69, v69
  v_mfma_f32_16x16x32_bf16 v[76:79], v[240:243], a[144:147], v[76:79]
  v_cvt_pk_bf16_f32 v66, v68, v69
  v_mfma_f32_16x16x32_bf16 v[84:87], v[240:243], a[160:163], v[84:87]
  v_exp_f32 v70, v70
  v_mfma_f32_16x16x32_bf16 v[92:95], v[240:243], a[176:179], v[92:95]
  buffer_load_dwordx4 v2, s[12:15], s29 offen offset:1024 nt lds
  v_mfma_f32_16x16x32_bf16 v[100:103], v[240:243], a[192:195], v[100:103]
  v_exp_f32 v71, v71
  v_mfma_f32_16x16x32_bf16 v[108:111], v[240:243], a[208:211], v[108:111]
  s_waitcnt lgkmcnt(0)
  v_cvt_pk_bf16_f32 v67, v70, v71
  v_mfma_f32_16x16x32_bf16 v[132:135], a[100:103], v[32:35], v[132:135]
  s_add_u32 m0, s27, 0x1c000
  v_exp_f32 v72, v72
  v_mfma_f32_16x16x32_bf16 v[148:151], a[100:103], v[40:43], v[148:151]
  buffer_load_dwordx4 v3, s[16:19], s30 offen nt lds
  v_mfma_f32_16x16x32_bf16 v[164:167], a[100:103], v[48:51], v[164:167]
  v_exp_f32 v73, v73
  v_mfma_f32_16x16x32_bf16 v[180:183], a[100:103], v[56:59], v[180:183]
  ds_read_b128 v[212:215], v5 offset:32768
  v_cvt_pk_bf16_f32 v72, v72, v73
  v_mfma_f32_16x16x32_bf16 v[196:199], a[100:103], v[64:67], v[196:199]
  v_exp_f32 v74, v74
  v_mfma_f32_16x16x32_bf16 v[136:139], a[104:107], v[32:35], v[136:139]
  buffer_load_dwordx4 v4, s[16:19], s30 offen offset:1024 nt lds
  v_mfma_f32_16x16x32_bf16 v[152:155], a[104:107], v[40:43], v[152:155]
  v_exp_f32 v75, v75
  v_mfma_f32_16x16x32_bf16 v[168:171], a[104:107], v[48:51], v[168:171]
  ds_read_b128 v[216:219], v6 offset:32768
  v_cvt_pk_bf16_f32 v73, v74, v75
  v_mfma_f32_16x16x32_bf16 v[184:187], a[104:107], v[56:59], v[184:187]
  s_add_u32 m0, s27, 0x1e000
  v_exp_f32 v80, v80
  v_mfma_f32_16x16x32_bf16 v[200:203], a[104:107], v[64:67], v[200:203]
  buffer_load_dwordx4 v3, s[16:19], s31 offen nt lds
  v_mfma_f32_16x16x32_bf16 v[140:143], a[108:111], v[32:35], v[140:143]
  v_exp_f32 v81, v81
  v_mfma_f32_16x16x32_bf16 v[156:159], a[108:111], v[40:43], v[156:159]
  ds_read_b128 v[220:223], v7 offset:32768
  v_cvt_pk_bf16_f32 v80, v80, v81
  v_mfma_f32_16x16x32_bf16 v[172:175], a[108:111], v[48:51], v[172:175]
  v_exp_f32 v82, v82
  v_mfma_f32_16x16x32_bf16 v[188:191], a[108:111], v[56:59], v[188:191]
  buffer_load_dwordx4 v4, s[16:19], s31 offen offset:1024 nt lds
  v_mfma_f32_16x16x32_bf16 v[204:207], a[108:111], v[64:67], v[204:207]
  v_exp_f32 v83, v83
  v_mfma_f32_16x16x32_bf16 v[144:147], a[112:115], v[32:35], v[144:147]
  ds_read_b128 v[224:227], v8 offset:32768
  v_cvt_pk_bf16_f32 v81, v82, v83
  v_mfma_f32_16x16x32_bf16 v[160:163], a[112:115], v[40:43], v[160:163]
  s_add_u32 s28, s28, 0x4000
  v_exp_f32 v88, v88
  v_mfma_f32_16x16x32_bf16 v[176:179], a[112:115], v[48:51], v[176:179]
  s_add_u32 s29, s29, 0x4000
  v_mfma_f32_16x16x32_bf16 v[192:195], a[112:115], v[56:59], v[192:195]
  s_add_u32 s30, s30, 0x4000
  v_exp_f32 v89, v89
  v_mfma_f32_16x16x32_bf16 v[208:211], a[112:115], v[64:67], v[208:211]
  s_add_u32 s31, s31, 0x4000
  ds_read_b128 v[228:231], v5 offset:36864
  v_cvt_pk_bf16_f32 v88, v88, v89
  v_mfma_f32_16x16x32_bf16 a[0:3], a[116:119], v[32:35], a[0:3]
  v_exp_f32 v90, v90
  v_mfma_f32_16x16x32_bf16 a[16:19], a[116:119], v[40:43], a[16:19]
  v_mfma_f32_16x16x32_bf16 a[32:35], a[116:119], v[48:51], a[32:35]
  v_exp_f32 v91, v91
  v_mfma_f32_16x16x32_bf16 a[48:51], a[116:119], v[56:59], a[48:51]
  ds_read_b128 v[232:235], v6 offset:36864
  v_cvt_pk_bf16_f32 v89, v90, v91
  v_mfma_f32_16x16x32_bf16 a[64:67], a[116:119], v[64:67], a[64:67]
  v_exp_f32 v96, v96
  v_mfma_f32_16x16x32_bf16 a[4:7], a[120:123], v[32:35], a[4:7]
  v_mfma_f32_16x16x32_bf16 a[20:23], a[120:123], v[40:43], a[20:23]
  v_exp_f32 v97, v97
  v_mfma_f32_16x16x32_bf16 a[36:39], a[120:123], v[48:51], a[36:39]
  ds_read_b128 v[236:239], v7 offset:36864
  v_cvt_pk_bf16_f32 v96, v96, v97
  v_mfma_f32_16x16x32_bf16 a[52:55], a[120:123], v[56:59], a[52:55]
  v_exp_f32 v98, v98
  v_mfma_f32_16x16x32_bf16 a[68:71], a[120:123], v[64:67], a[68:71]
  v_mfma_f32_16x16x32_bf16 a[8:11], a[124:127], v[32:35], a[8:11]
  v_exp_f32 v99, v99
  v_mfma_f32_16x16x32_bf16 a[24:27], a[124:127], v[40:43], a[24:27]
  ds_read_b128 v[240:243], v8 offset:36864
  v_cvt_pk_bf16_f32 v97, v98, v99
  v_mfma_f32_16x16x32_bf16 a[40:43], a[124:127], v[48:51], a[40:43]
  v_exp_f32 v104, v104
  v_mfma_f32_16x16x32_bf16 a[56:59], a[124:127], v[56:59], a[56:59]
  v_mfma_f32_16x16x32_bf16 a[72:75], a[124:127], v[64:67], a[72:75]
  v_exp_f32 v105, v105
  v_mfma_f32_16x16x32_bf16 a[12:15], a[128:131], v[32:35], a[12:15]
  v_cvt_pk_bf16_f32 v104, v104, v105
  v_mfma_f32_16x16x32_bf16 a[28:31], a[128:131], v[40:43], a[28:31]
  v_exp_f32 v106, v106
  v_mfma_f32_16x16x32_bf16 a[44:47], a[128:131], v[48:51], a[44:47]
  v_mfma_f32_16x16x32_bf16 a[60:63], a[128:131], v[56:59], a[60:63]
  v_exp_f32 v107, v107
  v_mfma_f32_16x16x32_bf16 a[76:79], a[128:131], v[64:67], a[76:79]
  v_cvt_pk_bf16_f32 v105, v106, v107
  v_mfma_f32_16x16x32_bf16 a[80:83], v[244:247], v[32:35], a[80:83]
  v_mfma_f32_16x16x32_bf16 a[84:87], v[244:247], v[40:43], a[84:87]
  v_mfma_f32_16x16x32_bf16 a[88:91], v[244:247], v[48:51], a[88:91]
  v_mfma_f32_16x16x32_bf16 a[92:95], v[244:247], v[56:59], a[92:95]
  v_mfma_f32_16x16x32_bf16 a[96:99], v[244:247], v[64:67], a[96:99]
  s_waitcnt vmcnt(16) lgkmcnt(0)
  s_barrier
  v_mfma_f32_16x16x32_bf16 v[32:35], v[212:215], a[132:135], v[112:115]
  v_exp_f32 v76, v76
  v_mfma_f32_16x16x32_bf16 v[40:43], v[212:215], a[148:151], v[116:119]
  ds_read_b64_tr_b16 a[100:101], v9 offset:16384
  ds_read_b64_tr_b16 a[102:103], v9 offset:20480
  v_mfma_f32_16x16x32_bf16 v[48:51], v[212:215], a[164:167], v[120:123]
  s_cmp_lt_u32 s28, 0x80000
  v_exp_f32 v77, v77
  v_mfma_f32_16x16x32_bf16 v[56:59], v[212:215], a[180:183], v[124:127]
  s_cselect_b32 s14, 0x80000, 0
  ds_read_b64_tr_b16 a[104:105], v10 offset:16384
  v_cvt_pk_bf16_f32 v74, v76, v77
  v_mfma_f32_16x16x32_bf16 v[64:67], v[212:215], a[196:199], v[128:131]
  s_cmp_lt_u32 s30, 0x80000
  v_exp_f32 v78, v78
  v_mfma_f32_16x16x32_bf16 v[32:35], v[216:219], a[136:139], v[32:35]
  s_cselect_b32 s18, 0x80000, 0
  ds_read_b64_tr_b16 a[106:107], v10 offset:20480
  ds_read_b64_tr_b16 a[108:109], v11 offset:16384
  v_mfma_f32_16x16x32_bf16 v[40:43], v[216:219], a[152:155], v[40:43]
  v_exp_f32 v79, v79
  v_mfma_f32_16x16x32_bf16 v[48:51], v[216:219], a[168:171], v[48:51]
  ds_read_b64_tr_b16 a[110:111], v11 offset:20480
  v_cvt_pk_bf16_f32 v75, v78, v79
  v_mfma_f32_16x16x32_bf16 v[56:59], v[216:219], a[184:187], v[56:59]
  v_exp_f32 v84, v84
  v_mfma_f32_16x16x32_bf16 v[64:67], v[216:219], a[200:203], v[64:67]
  ds_read_b64_tr_b16 a[112:113], v12 offset:16384
  ds_read_b64_tr_b16 a[114:115], v12 offset:20480
  v_mfma_f32_16x16x32_bf16 v[32:35], v[220:223], a[140:143], v[32:35]
  v_exp_f32 v85, v85
  v_mfma_f32_16x16x32_bf16 v[40:43], v[220:223], a[156:159], v[40:43]
  ds_read_b64_tr_b16 a[116:117], v13 offset:16384
  v_cvt_pk_bf16_f32 v82, v84, v85
  v_mfma_f32_16x16x32_bf16 v[48:51], v[220:223], a[172:175], v[48:51]
  v_exp_f32 v86, v86
  v_mfma_f32_16x16x32_bf16 v[56:59], v[220:223], a[188:191], v[56:59]
  ds_read_b64_tr_b16 a[118:119], v13 offset:20480
  ds_read_b64_tr_b16 a[120:121], v14 offset:16384
  v_mfma_f32_16x16x32_bf16 v[64:67], v[220:223], a[204:207], v[64:67]
  v_exp_f32 v87, v87
  v_mfma_f32_16x16x32_bf16 v[32:35], v[224:227], a[144:147], v[32:35]
  ds_read_b64_tr_b16 a[122:123], v14 offset:20480
  v_cvt_pk_bf16_f32 v83, v86, v87
  v_mfma_f32_16x16x32_bf16 v[40:43], v[224:227], a[160:163], v[40:43]
  v_exp_f32 v92, v92
  v_mfma_f32_16x16x32_bf16 v[48:51], v[224:227], a[176:179], v[48:51]
  ds_read_b64_tr_b16 a[124:125], v15 offset:16384
  ds_read_b64_tr_b16 a[126:127], v15 offset:20480
  v_mfma_f32_16x16x32_bf16 v[56:59], v[224:227], a[192:195], v[56:59]
  v_exp_f32 v93, v93
  v_mfma_f32_16x16x32_bf16 v[64:67], v[224:227], a[208:211], v[64:67]
  ds_read_b64_tr_b16 a[128:129], v16 offset:16384
  v_cvt_pk_bf16_f32 v90, v92, v93
  v_mfma_f32_16x16x32_bf16 v[36:39], v[228:231], a[132:135], v[112:115]
  v_exp_f32 v94, v94
  v_mfma_f32_16x16x32_bf16 v[44:47], v[228:231], a[148:151], v[116:119]
  ds_read_b64_tr_b16 a[130:131], v16 offset:20480
  v_mfma_f32_16x16x32_bf16 v[52:55], v[228:231], a[164:167], v[120:123]
  v_exp_f32 v95, v95
  v_mfma_f32_16x16x32_bf16 v[60:63], v[228:231], a[180:183], v[124:127]
  v_cvt_pk_bf16_f32 v91, v94, v95
  v_mfma_f32_16x16x32_bf16 v[68:71], v[228:231], a[196:199], v[128:131]
  s_add_u32 m0, s27, 0x8000
  v_exp_f32 v100, v100
  v_mfma_f32_16x16x32_bf16 v[36:39], v[232:235], a[136:139], v[36:39]
  buffer_load_dwordx4 v1, s[12:15], s28 offen nt lds
  v_mfma_f32_16x16x32_bf16 v[44:47], v[232:235], a[152:155], v[44:47]
  v_exp_f32 v101, v101
  v_mfma_f32_16x16x32_bf16 v[52:55], v[232:235], a[168:171], v[52:55]
  v_cvt_pk_bf16_f32 v98, v100, v101
  v_mfma_f32_16x16x32_bf16 v[60:63], v[232:235], a[184:187], v[60:63]
  v_exp_f32 v102, v102
  v_mfma_f32_16x16x32_bf16 v[68:71], v[232:235], a[200:203], v[68:71]
  buffer_load_dwordx4 v2, s[12:15], s28 offen offset:1024 nt lds
  v_mfma_f32_16x16x32_bf16 v[36:39], v[236:239], a[140:143], v[36:39]
  v_exp_f32 v103, v103
  v_mfma_f32_16x16x32_bf16 v[44:47], v[236:239], a[156:159], v[44:47]
  v_cvt_pk_bf16_f32 v99, v102, v103
  v_mfma_f32_16x16x32_bf16 v[52:55], v[236:239], a[172:175], v[52:55]
  s_add_u32 m0, s27, 0xa000
  v_exp_f32 v108, v108
  v_mfma_f32_16x16x32_bf16 v[60:63], v[236:239], a[188:191], v[60:63]
  buffer_load_dwordx4 v1, s[12:15], s29 offen nt lds
  v_mfma_f32_16x16x32_bf16 v[68:71], v[236:239], a[204:207], v[68:71]
  v_exp_f32 v109, v109
  v_mfma_f32_16x16x32_bf16 v[36:39], v[240:243], a[144:147], v[36:39]
  v_cvt_pk_bf16_f32 v106, v108, v109
  v_mfma_f32_16x16x32_bf16 v[44:47], v[240:243], a[160:163], v[44:47]
  v_exp_f32 v110, v110
  v_mfma_f32_16x16x32_bf16 v[52:55], v[240:243], a[176:179], v[52:55]
  buffer_load_dwordx4 v2, s[12:15], s29 offen offset:1024 nt lds
  v_mfma_f32_16x16x32_bf16 v[60:63], v[240:243], a[192:195], v[60:63]
  v_exp_f32 v111, v111
  v_mfma_f32_16x16x32_bf16 v[68:71], v[240:243], a[208:211], v[68:71]
  s_waitcnt lgkmcnt(0)
  v_cvt_pk_bf16_f32 v107, v110, v111
  v_mfma_f32_16x16x32_bf16 v[132:135], a[100:103], v[72:75], v[132:135]
  s_add_u32 m0, s27, 0x10000
  v_exp_f32 v32, v32
  v_mfma_f32_16x16x32_bf16 v[148:151], a[100:103], v[80:83], v[148:151]
  buffer_load_dwordx4 v3, s[16:19], s30 offen nt lds
  v_mfma_f32_16x16x32_bf16 v[164:167], a[100:103], v[88:91], v[164:167]
  v_exp_f32 v33, v33
  v_mfma_f32_16x16x32_bf16 v[180:183], a[100:103], v[96:99], v[180:183]
  ds_read_b128 v[212:215], v5 offset:49152
  v_cvt_pk_bf16_f32 v32, v32, v33
  v_mfma_f32_16x16x32_bf16 v[196:199], a[100:103], v[104:107], v[196:199]
  v_exp_f32 v34, v34
  v_mfma_f32_16x16x32_bf16 v[136:139], a[104:107], v[72:75], v[136:139]
  buffer_load_dwordx4 v4, s[16:19], s30 offen offset:1024 nt lds
  v_mfma_f32_16x16x32_bf16 v[152:155], a[104:107], v[80:83], v[152:155]
  v_exp_f32 v35, v35
  v_mfma_f32_16x16x32_bf16 v[168:171], a[104:107], v[88:91], v[168:171]
  ds_read_b128 v[216:219], v6 offset:49152
  v_cvt_pk_bf16_f32 v33, v34, v35
  v_mfma_f32_16x16x32_bf16 v[184:187], a[104:107], v[96:99], v[184:187]
  s_add_u32 m0, s27, 0x12000
  v_exp_f32 v40, v40
  v_mfma_f32_16x16x32_bf16 v[200:203], a[104:107], v[104:107], v[200:203]
  buffer_load_dwordx4 v3, s[16:19], s31 offen nt lds
  v_mfma_f32_16x16x32_bf16 v[140:143], a[108:111], v[72:75], v[140:143]
  v_exp_f32 v41, v41
  v_mfma_f32_16x16x32_bf16 v[156:159], a[108:111], v[80:83], v[156:159]
  ds_read_b128 v[220:223], v7 offset:49152
  v_cvt_pk_bf16_f32 v40, v40, v41
  v_mfma_f32_16x16x32_bf16 v[172:175], a[108:111], v[88:91], v[172:175]
  v_exp_f32 v42, v42
  v_mfma_f32_16x16x32_bf16 v[188:191], a[108:111], v[96:99], v[188:191]
  buffer_load_dwordx4 v4, s[16:19], s31 offen offset:1024 nt lds
  v_mfma_f32_16x16x32_bf16 v[204:207], a[108:111], v[104:107], v[204:207]
  v_exp_f32 v43, v43
  v_mfma_f32_16x16x32_bf16 v[144:147], a[112:115], v[72:75], v[144:147]
  ds_read_b128 v[224:227], v8 offset:49152
  v_cvt_pk_bf16_f32 v41, v42, v43
  v_mfma_f32_16x16x32_bf16 v[160:163], a[112:115], v[80:83], v[160:163]
  s_add_u32 s28, s28, 0x4000
  v_exp_f32 v48, v48
  v_mfma_f32_16x16x32_bf16 v[176:179], a[112:115], v[88:91], v[176:179]
  s_add_u32 s29, s29, 0x4000
  v_mfma_f32_16x16x32_bf16 v[192:195], a[112:115], v[96:99], v[192:195]
  s_add_u32 s30, s30, 0x4000
  v_exp_f32 v49, v49
  v_mfma_f32_16x16x32_bf16 v[208:211], a[112:115], v[104:107], v[208:211]
  s_add_u32 s31, s31, 0x4000
  ds_read_b128 v[228:231], v5 offset:53248
  v_cvt_pk_bf16_f32 v48, v48, v49
  v_mfma_f32_16x16x32_bf16 a[0:3], a[116:119], v[72:75], a[0:3]
  v_exp_f32 v50, v50
  v_mfma_f32_16x16x32_bf16 a[16:19], a[116:119], v[80:83], a[16:19]
  v_mfma_f32_16x16x32_bf16 a[32:35], a[116:119], v[88:91], a[32:35]
  v_exp_f32 v51, v51
  v_mfma_f32_16x16x32_bf16 a[48:51], a[116:119], v[96:99], a[48:51]
  ds_read_b128 v[232:235], v6 offset:53248
  v_cvt_pk_bf16_f32 v49, v50, v51
  v_mfma_f32_16x16x32_bf16 a[64:67], a[116:119], v[104:107], a[64:67]
  v_exp_f32 v56, v56
  v_mfma_f32_16x16x32_bf16 a[4:7], a[120:123], v[72:75], a[4:7]
  v_mfma_f32_16x16x32_bf16 a[20:23], a[120:123], v[80:83], a[20:23]
  v_exp_f32 v57, v57
  v_mfma_f32_16x16x32_bf16 a[36:39], a[120:123], v[88:91], a[36:39]
  ds_read_b128 v[236:239], v7 offset:53248
  v_cvt_pk_bf16_f32 v56, v56, v57
  v_mfma_f32_16x16x32_bf16 a[52:55], a[120:123], v[96:99], a[52:55]
  v_exp_f32 v58, v58
  v_mfma_f32_16x16x32_bf16 a[68:71], a[120:123], v[104:107], a[68:71]
  v_mfma_f32_16x16x32_bf16 a[8:11], a[124:127], v[72:75], a[8:11]
  v_exp_f32 v59, v59
  v_mfma_f32_16x16x32_bf16 a[24:27], a[124:127], v[80:83], a[24:27]
  ds_read_b128 v[240:243], v8 offset:53248
  v_cvt_pk_bf16_f32 v57, v58, v59
  v_mfma_f32_16x16x32_bf16 a[40:43], a[124:127], v[88:91], a[40:43]
  v_exp_f32 v64, v64
  v_mfma_f32_16x16x32_bf16 a[56:59], a[124:127], v[96:99], a[56:59]
  v_mfma_f32_16x16x32_bf16 a[72:75], a[124:127], v[104:107], a[72:75]
  v_exp_f32 v65, v65
  v_mfma_f32_16x16x32_bf16 a[12:15], a[128:131], v[72:75], a[12:15]
  v_cvt_pk_bf16_f32 v64, v64, v65
  v_mfma_f32_16x16x32_bf16 a[28:31], a[128:131], v[80:83], a[28:31]
  v_exp_f32 v66, v66
  v_mfma_f32_16x16x32_bf16 a[44:47], a[128:131], v[88:91], a[44:47]
  v_mfma_f32_16x16x32_bf16 a[60:63], a[128:131], v[96:99], a[60:63]
  v_exp_f32 v67, v67
  v_mfma_f32_16x16x32_bf16 a[76:79], a[128:131], v[104:107], a[76:79]
  v_cvt_pk_bf16_f32 v65, v66, v67
  v_mfma_f32_16x16x32_bf16 a[80:83], v[244:247], v[72:75], a[80:83]
  v_mfma_f32_16x16x32_bf16 a[84:87], v[244:247], v[80:83], a[84:87]
  v_mfma_f32_16x16x32_bf16 a[88:91], v[244:247], v[88:91], a[88:91]
  v_mfma_f32_16x16x32_bf16 a[92:95], v[244:247], v[96:99], a[92:95]
  v_mfma_f32_16x16x32_bf16 a[96:99], v[244:247], v[104:107], a[96:99]
  s_waitcnt vmcnt(16) lgkmcnt(0)
  s_barrier
  v_mfma_f32_16x16x32_bf16 v[72:75], v[212:215], a[132:135], v[112:115]
  v_exp_f32 v36, v36
  v_mfma_f32_16x16x32_bf16 v[80:83], v[212:215], a[148:151], v[116:119]
  ds_read_b64_tr_b16 a[100:101], v9 offset:32768
  ds_read_b64_tr_b16 a[102:103], v9 offset:36864
  v_mfma_f32_16x16x32_bf16 v[88:91], v[212:215], a[164:167], v[120:123]
  s_cmp_lt_u32 s28, 0x80000
  v_exp_f32 v37, v37
  v_mfma_f32_16x16x32_bf16 v[96:99], v[212:215], a[180:183], v[124:127]
  s_cselect_b32 s14, 0x80000, 0
  ds_read_b64_tr_b16 a[104:105], v10 offset:32768
  v_cvt_pk_bf16_f32 v34, v36, v37
  v_mfma_f32_16x16x32_bf16 v[104:107], v[212:215], a[196:199], v[128:131]
  s_cmp_lt_u32 s30, 0x80000
  v_exp_f32 v38, v38
  v_mfma_f32_16x16x32_bf16 v[72:75], v[216:219], a[136:139], v[72:75]
  s_cselect_b32 s18, 0x80000, 0
  ds_read_b64_tr_b16 a[106:107], v10 offset:36864
  ds_read_b64_tr_b16 a[108:109], v11 offset:32768
  v_mfma_f32_16x16x32_bf16 v[80:83], v[216:219], a[152:155], v[80:83]
  v_exp_f32 v39, v39
  v_mfma_f32_16x16x32_bf16 v[88:91], v[216:219], a[168:171], v[88:91]
  ds_read_b64_tr_b16 a[110:111], v11 offset:36864
  v_cvt_pk_bf16_f32 v35, v38, v39
  v_mfma_f32_16x16x32_bf16 v[96:99], v[216:219], a[184:187], v[96:99]
  v_exp_f32 v44, v44
  v_mfma_f32_16x16x32_bf16 v[104:107], v[216:219], a[200:203], v[104:107]
  ds_read_b64_tr_b16 a[112:113], v12 offset:32768
  ds_read_b64_tr_b16 a[114:115], v12 offset:36864
  v_mfma_f32_16x16x32_bf16 v[72:75], v[220:223], a[140:143], v[72:75]
  v_exp_f32 v45, v45
  v_mfma_f32_16x16x32_bf16 v[80:83], v[220:223], a[156:159], v[80:83]
  ds_read_b64_tr_b16 a[116:117], v13 offset:32768
  v_cvt_pk_bf16_f32 v42, v44, v45
  v_mfma_f32_16x16x32_bf16 v[88:91], v[220:223], a[172:175], v[88:91]
  v_exp_f32 v46, v46
  v_mfma_f32_16x16x32_bf16 v[96:99], v[220:223], a[188:191], v[96:99]
  ds_read_b64_tr_b16 a[118:119], v13 offset:36864
  ds_read_b64_tr_b16 a[120:121], v14 offset:32768
  v_mfma_f32_16x16x32_bf16 v[104:107], v[220:223], a[204:207], v[104:107]
  v_exp_f32 v47, v47
  v_mfma_f32_16x16x32_bf16 v[72:75], v[224:227], a[144:147], v[72:75]
  ds_read_b64_tr_b16 a[122:123], v14 offset:36864
  v_cvt_pk_bf16_f32 v43, v46, v47
  v_mfma_f32_16x16x32_bf16 v[80:83], v[224:227], a[160:163], v[80:83]
  v_exp_f32 v52, v52
  v_mfma_f32_16x16x32_bf16 v[88:91], v[224:227], a[176:179], v[88:91]
  ds_read_b64_tr_b16 a[124:125], v15 offset:32768
  ds_read_b64_tr_b16 a[126:127], v15 offset:36864
  v_mfma_f32_16x16x32_bf16 v[96:99], v[224:227], a[192:195], v[96:99]
  v_exp_f32 v53, v53
  v_mfma_f32_16x16x32_bf16 v[104:107], v[224:227], a[208:211], v[104:107]
  ds_read_b64_tr_b16 a[128:129], v16 offset:32768
  v_cvt_pk_bf16_f32 v50, v52, v53
  v_mfma_f32_16x16x32_bf16 v[76:79], v[228:231], a[132:135], v[112:115]
  v_exp_f32 v54, v54
  v_mfma_f32_16x16x32_bf16 v[84:87], v[228:231], a[148:151], v[116:119]
  ds_read_b64_tr_b16 a[130:131], v16 offset:36864
  v_mfma_f32_16x16x32_bf16 v[92:95], v[228:231], a[164:167], v[120:123]
  v_exp_f32 v55, v55
  v_mfma_f32_16x16x32_bf16 v[100:103], v[228:231], a[180:183], v[124:127]
  v_cvt_pk_bf16_f32 v51, v54, v55
  v_mfma_f32_16x16x32_bf16 v[108:111], v[228:231], a[196:199], v[128:131]
  s_add_u32 m0, s27, 0xc000
  v_exp_f32 v60, v60
  v_mfma_f32_16x16x32_bf16 v[76:79], v[232:235], a[136:139], v[76:79]
  buffer_load_dwordx4 v1, s[12:15], s28 offen nt lds
  v_mfma_f32_16x16x32_bf16 v[84:87], v[232:235], a[152:155], v[84:87]
  v_exp_f32 v61, v61
  v_mfma_f32_16x16x32_bf16 v[92:95], v[232:235], a[168:171], v[92:95]
  v_cvt_pk_bf16_f32 v58, v60, v61
  v_mfma_f32_16x16x32_bf16 v[100:103], v[232:235], a[184:187], v[100:103]
  v_exp_f32 v62, v62
  v_mfma_f32_16x16x32_bf16 v[108:111], v[232:235], a[200:203], v[108:111]
  buffer_load_dwordx4 v2, s[12:15], s28 offen offset:1024 nt lds
  v_mfma_f32_16x16x32_bf16 v[76:79], v[236:239], a[140:143], v[76:79]
  v_exp_f32 v63, v63
  v_mfma_f32_16x16x32_bf16 v[84:87], v[236:239], a[156:159], v[84:87]
  v_cvt_pk_bf16_f32 v59, v62, v63
  v_mfma_f32_16x16x32_bf16 v[92:95], v[236:239], a[172:175], v[92:95]
  s_add_u32 m0, s27, 0xe000
  v_exp_f32 v68, v68
  v_mfma_f32_16x16x32_bf16 v[100:103], v[236:239], a[188:191], v[100:103]
  buffer_load_dwordx4 v1, s[12:15], s29 offen nt lds
  v_mfma_f32_16x16x32_bf16 v[108:111], v[236:239], a[204:207], v[108:111]
  v_exp_f32 v69, v69
  v_mfma_f32_16x16x32_bf16 v[76:79], v[240:243], a[144:147], v[76:79]
  v_cvt_pk_bf16_f32 v66, v68, v69
  v_mfma_f32_16x16x32_bf16 v[84:87], v[240:243], a[160:163], v[84:87]
  v_exp_f32 v70, v70
  v_mfma_f32_16x16x32_bf16 v[92:95], v[240:243], a[176:179], v[92:95]
  buffer_load_dwordx4 v2, s[12:15], s29 offen offset:1024 nt lds
  v_mfma_f32_16x16x32_bf16 v[100:103], v[240:243], a[192:195], v[100:103]
  v_exp_f32 v71, v71
  v_mfma_f32_16x16x32_bf16 v[108:111], v[240:243], a[208:211], v[108:111]
  s_waitcnt lgkmcnt(0)
  v_cvt_pk_bf16_f32 v67, v70, v71
  v_mfma_f32_16x16x32_bf16 v[132:135], a[100:103], v[32:35], v[132:135]
  s_add_u32 m0, s27, 0x14000
  v_exp_f32 v72, v72
  v_mfma_f32_16x16x32_bf16 v[148:151], a[100:103], v[40:43], v[148:151]
  buffer_load_dwordx4 v3, s[16:19], s30 offen nt lds
  v_mfma_f32_16x16x32_bf16 v[164:167], a[100:103], v[48:51], v[164:167]
  v_exp_f32 v73, v73
  v_mfma_f32_16x16x32_bf16 v[180:183], a[100:103], v[56:59], v[180:183]
  ds_read_b128 v[212:215], v5 offset:0
  v_cvt_pk_bf16_f32 v72, v72, v73
  v_mfma_f32_16x16x32_bf16 v[196:199], a[100:103], v[64:67], v[196:199]
  v_exp_f32 v74, v74
  v_mfma_f32_16x16x32_bf16 v[136:139], a[104:107], v[32:35], v[136:139]
  buffer_load_dwordx4 v4, s[16:19], s30 offen offset:1024 nt lds
  v_mfma_f32_16x16x32_bf16 v[152:155], a[104:107], v[40:43], v[152:155]
  v_exp_f32 v75, v75
  v_mfma_f32_16x16x32_bf16 v[168:171], a[104:107], v[48:51], v[168:171]
  ds_read_b128 v[216:219], v6 offset:0
  v_cvt_pk_bf16_f32 v73, v74, v75
  v_mfma_f32_16x16x32_bf16 v[184:187], a[104:107], v[56:59], v[184:187]
  s_add_u32 m0, s27, 0x16000
  v_exp_f32 v80, v80
  v_mfma_f32_16x16x32_bf16 v[200:203], a[104:107], v[64:67], v[200:203]
  buffer_load_dwordx4 v3, s[16:19], s31 offen nt lds
  v_mfma_f32_16x16x32_bf16 v[140:143], a[108:111], v[32:35], v[140:143]
  v_exp_f32 v81, v81
  v_mfma_f32_16x16x32_bf16 v[156:159], a[108:111], v[40:43], v[156:159]
  ds_read_b128 v[220:223], v7 offset:0
  v_cvt_pk_bf16_f32 v80, v80, v81
  v_mfma_f32_16x16x32_bf16 v[172:175], a[108:111], v[48:51], v[172:175]
  v_exp_f32 v82, v82
  v_mfma_f32_16x16x32_bf16 v[188:191], a[108:111], v[56:59], v[188:191]
  buffer_load_dwordx4 v4, s[16:19], s31 offen offset:1024 nt lds
  v_mfma_f32_16x16x32_bf16 v[204:207], a[108:111], v[64:67], v[204:207]
  v_exp_f32 v83, v83
  v_mfma_f32_16x16x32_bf16 v[144:147], a[112:115], v[32:35], v[144:147]
  ds_read_b128 v[224:227], v8 offset:0
  v_cvt_pk_bf16_f32 v81, v82, v83
  v_mfma_f32_16x16x32_bf16 v[160:163], a[112:115], v[40:43], v[160:163]
  s_add_u32 s28, s28, 0x4000
  v_exp_f32 v88, v88
  v_mfma_f32_16x16x32_bf16 v[176:179], a[112:115], v[48:51], v[176:179]
  s_add_u32 s29, s29, 0x4000
  v_mfma_f32_16x16x32_bf16 v[192:195], a[112:115], v[56:59], v[192:195]
  s_add_u32 s30, s30, 0x4000
  v_exp_f32 v89, v89
  v_mfma_f32_16x16x32_bf16 v[208:211], a[112:115], v[64:67], v[208:211]
  s_add_u32 s31, s31, 0x4000
  ds_read_b128 v[228:231], v5 offset:4096
  v_cvt_pk_bf16_f32 v88, v88, v89
  v_mfma_f32_16x16x32_bf16 a[0:3], a[116:119], v[32:35], a[0:3]
  v_exp_f32 v90, v90
  v_mfma_f32_16x16x32_bf16 a[16:19], a[116:119], v[40:43], a[16:19]
  v_mfma_f32_16x16x32_bf16 a[32:35], a[116:119], v[48:51], a[32:35]
  v_exp_f32 v91, v91
  v_mfma_f32_16x16x32_bf16 a[48:51], a[116:119], v[56:59], a[48:51]
  ds_read_b128 v[232:235], v6 offset:4096
  v_cvt_pk_bf16_f32 v89, v90, v91
  v_mfma_f32_16x16x32_bf16 a[64:67], a[116:119], v[64:67], a[64:67]
  v_exp_f32 v96, v96
  v_mfma_f32_16x16x32_bf16 a[4:7], a[120:123], v[32:35], a[4:7]
  v_mfma_f32_16x16x32_bf16 a[20:23], a[120:123], v[40:43], a[20:23]
  v_exp_f32 v97, v97
  v_mfma_f32_16x16x32_bf16 a[36:39], a[120:123], v[48:51], a[36:39]
  ds_read_b128 v[236:239], v7 offset:4096
  v_cvt_pk_bf16_f32 v96, v96, v97
  v_mfma_f32_16x16x32_bf16 a[52:55], a[120:123], v[56:59], a[52:55]
  v_exp_f32 v98, v98
  v_mfma_f32_16x16x32_bf16 a[68:71], a[120:123], v[64:67], a[68:71]
  v_mfma_f32_16x16x32_bf16 a[8:11], a[124:127], v[32:35], a[8:11]
  v_exp_f32 v99, v99
  v_mfma_f32_16x16x32_bf16 a[24:27], a[124:127], v[40:43], a[24:27]
  ds_read_b128 v[240:243], v8 offset:4096
  v_cvt_pk_bf16_f32 v97, v98, v99
  v_mfma_f32_16x16x32_bf16 a[40:43], a[124:127], v[48:51], a[40:43]
  v_exp_f32 v104, v104
  v_mfma_f32_16x16x32_bf16 a[56:59], a[124:127], v[56:59], a[56:59]
  v_mfma_f32_16x16x32_bf16 a[72:75], a[124:127], v[64:67], a[72:75]
  v_exp_f32 v105, v105
  v_mfma_f32_16x16x32_bf16 a[12:15], a[128:131], v[32:35], a[12:15]
  v_cvt_pk_bf16_f32 v104, v104, v105
  v_mfma_f32_16x16x32_bf16 a[28:31], a[128:131], v[40:43], a[28:31]
  v_exp_f32 v106, v106
  v_mfma_f32_16x16x32_bf16 a[44:47], a[128:131], v[48:51], a[44:47]
  v_mfma_f32_16x16x32_bf16 a[60:63], a[128:131], v[56:59], a[60:63]
  v_exp_f32 v107, v107
  v_mfma_f32_16x16x32_bf16 a[76:79], a[128:131], v[64:67], a[76:79]
  v_cvt_pk_bf16_f32 v105, v106, v107
  v_mfma_f32_16x16x32_bf16 a[80:83], v[244:247], v[32:35], a[80:83]
  v_mfma_f32_16x16x32_bf16 a[84:87], v[244:247], v[40:43], a[84:87]
  v_mfma_f32_16x16x32_bf16 a[88:91], v[244:247], v[48:51], a[88:91]
  v_mfma_f32_16x16x32_bf16 a[92:95], v[244:247], v[56:59], a[92:95]
  v_mfma_f32_16x16x32_bf16 a[96:99], v[244:247], v[64:67], a[96:99]
  s_waitcnt vmcnt(16) lgkmcnt(0)
  s_barrier
  v_mfma_f32_16x16x32_bf16 v[32:35], v[212:215], a[132:135], v[112:115]
  v_exp_f32 v76, v76
  v_mfma_f32_16x16x32_bf16 v[40:43], v[212:215], a[148:151], v[116:119]
  ds_read_b64_tr_b16 a[100:101], v9 offset:49152
  ds_read_b64_tr_b16 a[102:103], v9 offset:53248
  v_mfma_f32_16x16x32_bf16 v[48:51], v[212:215], a[164:167], v[120:123]
  s_cmp_lt_u32 s28, 0x80000
  v_exp_f32 v77, v77
  v_mfma_f32_16x16x32_bf16 v[56:59], v[212:215], a[180:183], v[124:127]
  s_cselect_b32 s14, 0x80000, 0
  ds_read_b64_tr_b16 a[104:105], v10 offset:49152
  v_cvt_pk_bf16_f32 v74, v76, v77
  v_mfma_f32_16x16x32_bf16 v[64:67], v[212:215], a[196:199], v[128:131]
  s_cmp_lt_u32 s30, 0x80000
  v_exp_f32 v78, v78
  v_mfma_f32_16x16x32_bf16 v[32:35], v[216:219], a[136:139], v[32:35]
  s_cselect_b32 s18, 0x80000, 0
  ds_read_b64_tr_b16 a[106:107], v10 offset:53248
  ds_read_b64_tr_b16 a[108:109], v11 offset:49152
  v_mfma_f32_16x16x32_bf16 v[40:43], v[216:219], a[152:155], v[40:43]
  v_exp_f32 v79, v79
  v_mfma_f32_16x16x32_bf16 v[48:51], v[216:219], a[168:171], v[48:51]
  ds_read_b64_tr_b16 a[110:111], v11 offset:53248
  v_cvt_pk_bf16_f32 v75, v78, v79
  v_mfma_f32_16x16x32_bf16 v[56:59], v[216:219], a[184:187], v[56:59]
  v_exp_f32 v84, v84
  v_mfma_f32_16x16x32_bf16 v[64:67], v[216:219], a[200:203], v[64:67]
  ds_read_b64_tr_b16 a[112:113], v12 offset:49152
  ds_read_b64_tr_b16 a[114:115], v12 offset:53248
  v_mfma_f32_16x16x32_bf16 v[32:35], v[220:223], a[140:143], v[32:35]
  v_exp_f32 v85, v85
  v_mfma_f32_16x16x32_bf16 v[40:43], v[220:223], a[156:159], v[40:43]
  ds_read_b64_tr_b16 a[116:117], v13 offset:49152
  v_cvt_pk_bf16_f32 v82, v84, v85
  v_mfma_f32_16x16x32_bf16 v[48:51], v[220:223], a[172:175], v[48:51]
  v_exp_f32 v86, v86
  v_mfma_f32_16x16x32_bf16 v[56:59], v[220:223], a[188:191], v[56:59]
  ds_read_b64_tr_b16 a[118:119], v13 offset:53248
  ds_read_b64_tr_b16 a[120:121], v14 offset:49152
  v_mfma_f32_16x16x32_bf16 v[64:67], v[220:223], a[204:207], v[64:67]
  v_exp_f32 v87, v87
  v_mfma_f32_16x16x32_bf16 v[32:35], v[224:227], a[144:147], v[32:35]
  ds_read_b64_tr_b16 a[122:123], v14 offset:53248
  v_cvt_pk_bf16_f32 v83, v86, v87
  v_mfma_f32_16x16x32_bf16 v[40:43], v[224:227], a[160:163], v[40:43]
  v_exp_f32 v92, v92
  v_mfma_f32_16x16x32_bf16 v[48:51], v[224:227], a[176:179], v[48:51]
  ds_read_b64_tr_b16 a[124:125], v15 offset:49152
  ds_read_b64_tr_b16 a[126:127], v15 offset:53248
  v_mfma_f32_16x16x32_bf16 v[56:59], v[224:227], a[192:195], v[56:59]
  v_exp_f32 v93, v93
  v_mfma_f32_16x16x32_bf16 v[64:67], v[224:227], a[208:211], v[64:67]
  ds_read_b64_tr_b16 a[128:129], v16 offset:49152
  v_cvt_pk_bf16_f32 v90, v92, v93
  v_mfma_f32_16x16x32_bf16 v[36:39], v[228:231], a[132:135], v[112:115]
  v_exp_f32 v94, v94
  v_mfma_f32_16x16x32_bf16 v[44:47], v[228:231], a[148:151], v[116:119]
  ds_read_b64_tr_b16 a[130:131], v16 offset:53248
  v_mfma_f32_16x16x32_bf16 v[52:55], v[228:231], a[164:167], v[120:123]
  v_exp_f32 v95, v95
  v_mfma_f32_16x16x32_bf16 v[60:63], v[228:231], a[180:183], v[124:127]
  v_cvt_pk_bf16_f32 v91, v94, v95
  v_mfma_f32_16x16x32_bf16 v[68:71], v[228:231], a[196:199], v[128:131]
  s_add_u32 m0, s27, 0x0
  v_exp_f32 v100, v100
  v_mfma_f32_16x16x32_bf16 v[36:39], v[232:235], a[136:139], v[36:39]
  buffer_load_dwordx4 v1, s[12:15], s28 offen nt lds
  v_mfma_f32_16x16x32_bf16 v[44:47], v[232:235], a[152:155], v[44:47]
  v_exp_f32 v101, v101
  v_mfma_f32_16x16x32_bf16 v[52:55], v[232:235], a[168:171], v[52:55]
  v_cvt_pk_bf16_f32 v98, v100, v101
  v_mfma_f32_16x16x32_bf16 v[60:63], v[232:235], a[184:187], v[60:63]
  v_exp_f32 v102, v102
  v_mfma_f32_16x16x32_bf16 v[68:71], v[232:235], a[200:203], v[68:71]
  buffer_load_dwordx4 v2, s[12:15], s28 offen offset:1024 nt lds
  v_mfma_f32_16x16x32_bf16 v[36:39], v[236:239], a[140:143], v[36:39]
  v_exp_f32 v103, v103
  v_mfma_f32_16x16x32_bf16 v[44:47], v[236:239], a[156:159], v[44:47]
  v_cvt_pk_bf16_f32 v99, v102, v103
  v_mfma_f32_16x16x32_bf16 v[52:55], v[236:239], a[172:175], v[52:55]
  s_add_u32 m0, s27, 0x2000
  v_exp_f32 v108, v108
  v_mfma_f32_16x16x32_bf16 v[60:63], v[236:239], a[188:191], v[60:63]
  buffer_load_dwordx4 v1, s[12:15], s29 offen nt lds
  v_mfma_f32_16x16x32_bf16 v[68:71], v[236:239], a[204:207], v[68:71]
  v_exp_f32 v109, v109
  v_mfma_f32_16x16x32_bf16 v[36:39], v[240:243], a[144:147], v[36:39]
  v_cvt_pk_bf16_f32 v106, v108, v109
  v_mfma_f32_16x16x32_bf16 v[44:47], v[240:243], a[160:163], v[44:47]
  v_exp_f32 v110, v110
  v_mfma_f32_16x16x32_bf16 v[52:55], v[240:243], a[176:179], v[52:55]
  buffer_load_dwordx4 v2, s[12:15], s29 offen offset:1024 nt lds
  v_mfma_f32_16x16x32_bf16 v[60:63], v[240:243], a[192:195], v[60:63]
  v_exp_f32 v111, v111
  v_mfma_f32_16x16x32_bf16 v[68:71], v[240:243], a[208:211], v[68:71]
  s_waitcnt lgkmcnt(0)
  v_cvt_pk_bf16_f32 v107, v110, v111
  v_mfma_f32_16x16x32_bf16 v[132:135], a[100:103], v[72:75], v[132:135]
  s_add_u32 m0, s27, 0x18000
  v_exp_f32 v32, v32
  v_mfma_f32_16x16x32_bf16 v[148:151], a[100:103], v[80:83], v[148:151]
  buffer_load_dwordx4 v3, s[16:19], s30 offen nt lds
  v_mfma_f32_16x16x32_bf16 v[164:167], a[100:103], v[88:91], v[164:167]
  v_exp_f32 v33, v33
  v_mfma_f32_16x16x32_bf16 v[180:183], a[100:103], v[96:99], v[180:183]
  ds_read_b128 v[212:215], v5 offset:16384
  v_cvt_pk_bf16_f32 v32, v32, v33
  v_mfma_f32_16x16x32_bf16 v[196:199], a[100:103], v[104:107], v[196:199]
  v_exp_f32 v34, v34
  v_mfma_f32_16x16x32_bf16 v[136:139], a[104:107], v[72:75], v[136:139]
  buffer_load_dwordx4 v4, s[16:19], s30 offen offset:1024 nt lds
  v_mfma_f32_16x16x32_bf16 v[152:155], a[104:107], v[80:83], v[152:155]
  v_exp_f32 v35, v35
  v_mfma_f32_16x16x32_bf16 v[168:171], a[104:107], v[88:91], v[168:171]
  ds_read_b128 v[216:219], v6 offset:16384
  v_cvt_pk_bf16_f32 v33, v34, v35
  v_mfma_f32_16x16x32_bf16 v[184:187], a[104:107], v[96:99], v[184:187]
  s_add_u32 m0, s27, 0x1a000
  v_exp_f32 v40, v40
  v_mfma_f32_16x16x32_bf16 v[200:203], a[104:107], v[104:107], v[200:203]
  buffer_load_dwordx4 v3, s[16:19], s31 offen nt lds
  v_mfma_f32_16x16x32_bf16 v[140:143], a[108:111], v[72:75], v[140:143]
  v_exp_f32 v41, v41
  v_mfma_f32_16x16x32_bf16 v[156:159], a[108:111], v[80:83], v[156:159]
  ds_read_b128 v[220:223], v7 offset:16384
  v_cvt_pk_bf16_f32 v40, v40, v41
  v_mfma_f32_16x16x32_bf16 v[172:175], a[108:111], v[88:91], v[172:175]
  v_exp_f32 v42, v42
  v_mfma_f32_16x16x32_bf16 v[188:191], a[108:111], v[96:99], v[188:191]
  buffer_load_dwordx4 v4, s[16:19], s31 offen offset:1024 nt lds
  v_mfma_f32_16x16x32_bf16 v[204:207], a[108:111], v[104:107], v[204:207]
  v_exp_f32 v43, v43
  v_mfma_f32_16x16x32_bf16 v[144:147], a[112:115], v[72:75], v[144:147]
  ds_read_b128 v[224:227], v8 offset:16384
  v_cvt_pk_bf16_f32 v41, v42, v43
  v_mfma_f32_16x16x32_bf16 v[160:163], a[112:115], v[80:83], v[160:163]
  s_add_u32 s28, s28, 0x4000
  v_exp_f32 v48, v48
  v_mfma_f32_16x16x32_bf16 v[176:179], a[112:115], v[88:91], v[176:179]
  s_add_u32 s29, s29, 0x4000
  v_mfma_f32_16x16x32_bf16 v[192:195], a[112:115], v[96:99], v[192:195]
  s_add_u32 s30, s30, 0x4000
  v_exp_f32 v49, v49
  v_mfma_f32_16x16x32_bf16 v[208:211], a[112:115], v[104:107], v[208:211]
  s_add_u32 s31, s31, 0x4000
  ds_read_b128 v[228:231], v5 offset:20480
  v_cvt_pk_bf16_f32 v48, v48, v49
  v_mfma_f32_16x16x32_bf16 a[0:3], a[116:119], v[72:75], a[0:3]
  v_exp_f32 v50, v50
  v_mfma_f32_16x16x32_bf16 a[16:19], a[116:119], v[80:83], a[16:19]
  v_mfma_f32_16x16x32_bf16 a[32:35], a[116:119], v[88:91], a[32:35]
  v_exp_f32 v51, v51
  v_mfma_f32_16x16x32_bf16 a[48:51], a[116:119], v[96:99], a[48:51]
  ds_read_b128 v[232:235], v6 offset:20480
  v_cvt_pk_bf16_f32 v49, v50, v51
  v_mfma_f32_16x16x32_bf16 a[64:67], a[116:119], v[104:107], a[64:67]
  v_exp_f32 v56, v56
  v_mfma_f32_16x16x32_bf16 a[4:7], a[120:123], v[72:75], a[4:7]
  v_mfma_f32_16x16x32_bf16 a[20:23], a[120:123], v[80:83], a[20:23]
  v_exp_f32 v57, v57
  v_mfma_f32_16x16x32_bf16 a[36:39], a[120:123], v[88:91], a[36:39]
  ds_read_b128 v[236:239], v7 offset:20480
  v_cvt_pk_bf16_f32 v56, v56, v57
  v_mfma_f32_16x16x32_bf16 a[52:55], a[120:123], v[96:99], a[52:55]
  v_exp_f32 v58, v58
  v_mfma_f32_16x16x32_bf16 a[68:71], a[120:123], v[104:107], a[68:71]
  v_mfma_f32_16x16x32_bf16 a[8:11], a[124:127], v[72:75], a[8:11]
  v_exp_f32 v59, v59
  v_mfma_f32_16x16x32_bf16 a[24:27], a[124:127], v[80:83], a[24:27]
  ds_read_b128 v[240:243], v8 offset:20480
  v_cvt_pk_bf16_f32 v57, v58, v59
  v_mfma_f32_16x16x32_bf16 a[40:43], a[124:127], v[88:91], a[40:43]
  v_exp_f32 v64, v64
  v_mfma_f32_16x16x32_bf16 a[56:59], a[124:127], v[96:99], a[56:59]
  v_mfma_f32_16x16x32_bf16 a[72:75], a[124:127], v[104:107], a[72:75]
  v_exp_f32 v65, v65
  v_mfma_f32_16x16x32_bf16 a[12:15], a[128:131], v[72:75], a[12:15]
  v_cvt_pk_bf16_f32 v64, v64, v65
  v_mfma_f32_16x16x32_bf16 a[28:31], a[128:131], v[80:83], a[28:31]
  v_exp_f32 v66, v66
  v_mfma_f32_16x16x32_bf16 a[44:47], a[128:131], v[88:91], a[44:47]
  v_mfma_f32_16x16x32_bf16 a[60:63], a[128:131], v[96:99], a[60:63]
  v_exp_f32 v67, v67
  v_mfma_f32_16x16x32_bf16 a[76:79], a[128:131], v[104:107], a[76:79]
  v_cvt_pk_bf16_f32 v65, v66, v67
  v_mfma_f32_16x16x32_bf16 a[80:83], v[244:247], v[72:75], a[80:83]
  v_mfma_f32_16x16x32_bf16 a[84:87], v[244:247], v[80:83], a[84:87]
  v_mfma_f32_16x16x32_bf16 a[88:91], v[244:247], v[88:91], a[88:91]
  s_sub_u32 s32, s32, 1
  v_mfma_f32_16x16x32_bf16 a[92:95], v[244:247], v[96:99], a[92:95]
  v_mfma_f32_16x16x32_bf16 a[96:99], v[244:247], v[104:107], a[96:99]
  s_bitcmp1_b32 s101, s32
  s_cbranch_scc0 L_loop
  s_cmp_lg_u32 s32, 0
  s_cbranch_scc1 L_special
L_loop_exit:
L_tail_begin:
  v_readfirstlane_b32 s35, v31
  s_nop 0
  s_cmp_lg_u32 s35, 256
  s_cbranch_scc1 L_wspin
L_wok:
  s_waitcnt vmcnt(16) lgkmcnt(0)
  s_barrier
  v_mfma_f32_16x16x32_bf16 v[72:75], v[212:215], a[132:135], v[112:115]
  v_exp_f32 v36, v36
  v_mfma_f32_16x16x32_bf16 v[80:83], v[212:215], a[148:151], v[116:119]
  ds_read_b64_tr_b16 a[100:101], v9 offset:0
  ds_read_b64_tr_b16 a[102:103], v9 offset:4096
  v_mfma_f32_16x16x32_bf16 v[88:91], v[212:215], a[164:167], v[120:123]
  v_exp_f32 v37, v37
  v_mfma_f32_16x16x32_bf16 v[96:99], v[212:215], a[180:183], v[124:127]
  ds_read_b64_tr_b16 a[104:105], v10 offset:0
  v_cvt_pk_bf16_f32 v34, v36, v37
  v_mfma_f32_16x16x32_bf16 v[104:107], v[212:215], a[196:199], v[128:131]
  v_exp_f32 v38, v38
  v_mfma_f32_16x16x32_bf16 v[72:75], v[216:219], a[136:139], v[72:75]
  ds_read_b64_tr_b16 a[106:107], v10 offset:4096
  ds_read_b64_tr_b16 a[108:109], v11 offset:0
  v_mfma_f32_16x16x32_bf16 v[80:83], v[216:219], a[152:155], v[80:83]
  s_lshr_b32 s10, s2, 1
  v_exp_f32 v39, v39
  v_mfma_f32_16x16x32_bf16 v[88:91], v[216:219], a[168:171], v[88:91]
  s_mul_i32 s10, s10, 36864
  ds_read_b64_tr_b16 a[110:111], v11 offset:4096
  v_cvt_pk_bf16_f32 v35, v38, v39
  v_mfma_f32_16x16x32_bf16 v[96:99], v[216:219], a[184:187], v[96:99]
  s_and_b32 s11, s2, 1
  v_exp_f32 v44, v44
  v_mfma_f32_16x16x32_bf16 v[104:107], v[216:219], a[200:203], v[104:107]
  s_mul_i32 s11, s11, 576
  ds_read_b64_tr_b16 a[112:113], v12 offset:0
  ds_read_b64_tr_b16 a[114:115], v12 offset:4096
  v_mfma_f32_16x16x32_bf16 v[72:75], v[220:223], a[140:143], v[72:75]
  s_add_u32 s10, s10, s11
  v_exp_f32 v45, v45
  v_mfma_f32_16x16x32_bf16 v[80:83], v[220:223], a[156:159], v[80:83]
  s_sub_u32 s92, s92, s10
  s_subb_u32 s93, s93, 0
  ds_read_b64_tr_b16 a[116:117], v13 offset:0
  v_cvt_pk_bf16_f32 v42, v44, v45
  v_mfma_f32_16x16x32_bf16 v[88:91], v[220:223], a[172:175], v[88:91]
  v_exp_f32 v46, v46
  v_mfma_f32_16x16x32_bf16 v[96:99], v[220:223], a[188:191], v[96:99]
  ds_read_b64_tr_b16 a[118:119], v13 offset:4096
  ds_read_b64_tr_b16 a[120:121], v14 offset:0
  v_mfma_f32_16x16x32_bf16 v[104:107], v[220:223], a[204:207], v[104:107]
  v_exp_f32 v47, v47
  v_mfma_f32_16x16x32_bf16 v[72:75], v[224:227], a[144:147], v[72:75]
  ds_read_b64_tr_b16 a[122:123], v14 offset:4096
  v_cvt_pk_bf16_f32 v43, v46, v47
  v_mfma_f32_16x16x32_bf16 v[80:83], v[224:227], a[160:163], v[80:83]
  v_exp_f32 v52, v52
  v_mfma_f32_16x16x32_bf16 v[88:91], v[224:227], a[176:179], v[88:91]
  ds_read_b64_tr_b16 a[124:125], v15 offset:0
  ds_read_b64_tr_b16 a[126:127], v15 offset:4096
  v_mfma_f32_16x16x32_bf16 v[96:99], v[224:227], a[192:195], v[96:99]
  v_exp_f32 v53, v53
  v_mfma_f32_16x16x32_bf16 v[104:107], v[224:227], a[208:211], v[104:107]
  ds_read_b64_tr_b16 a[128:129], v16 offset:0
  v_cvt_pk_bf16_f32 v50, v52, v53
  v_mfma_f32_16x16x32_bf16 v[76:79], v[228:231], a[132:135], v[112:115]
  v_exp_f32 v54, v54
  v_mfma_f32_16x16x32_bf16 v[84:87], v[228:231], a[148:151], v[116:119]
  ds_read_b64_tr_b16 a[130:131], v16 offset:4096
  v_mfma_f32_16x16x32_bf16 v[92:95], v[228:231], a[164:167], v[120:123]
  v_exp_f32 v55, v55
  v_mfma_f32_16x16x32_bf16 v[100:103], v[228:231], a[180:183], v[124:127]
  v_cvt_pk_bf16_f32 v51, v54, v55
  v_mfma_f32_16x16x32_bf16 v[108:111], v[228:231], a[196:199], v[128:131]
  s_add_u32 m0, s27, 0x1c000
  v_exp_f32 v60, v60
  v_mfma_f32_16x16x32_bf16 v[76:79], v[232:235], a[136:139], v[76:79]
  buffer_load_dwordx4 v3, s[16:19], s30 offen nt lds
  v_mfma_f32_16x16x32_bf16 v[84:87], v[232:235], a[152:155], v[84:87]
  v_exp_f32 v61, v61
  v_mfma_f32_16x16x32_bf16 v[92:95], v[232:235], a[168:171], v[92:95]
  v_cvt_pk_bf16_f32 v58, v60, v61
  v_mfma_f32_16x16x32_bf16 v[100:103], v[232:235], a[184:187], v[100:103]
  v_exp_f32 v62, v62
  v_mfma_f32_16x16x32_bf16 v[108:111], v[232:235], a[200:203], v[108:111]
  buffer_load_dwordx4 v4, s[16:19], s30 offen offset:1024 nt lds
  v_mfma_f32_16x16x32_bf16 v[76:79], v[236:239], a[140:143], v[76:79]
  v_exp_f32 v63, v63
  v_mfma_f32_16x16x32_bf16 v[84:87], v[236:239], a[156:159], v[84:87]
  v_cvt_pk_bf16_f32 v59, v62, v63
  v_mfma_f32_16x16x32_bf16 v[92:95], v[236:239], a[172:175], v[92:95]
  s_add_u32 m0, s27, 0x1e000
  v_exp_f32 v68, v68
  v_mfma_f32_16x16x32_bf16 v[100:103], v[236:239], a[188:191], v[100:103]
  buffer_load_dwordx4 v3, s[16:19], s31 offen nt lds
  v_mfma_f32_16x16x32_bf16 v[108:111], v[236:239], a[204:207], v[108:111]
  v_exp_f32 v69, v69
  v_mfma_f32_16x16x32_bf16 v[76:79], v[240:243], a[144:147], v[76:79]
  v_cvt_pk_bf16_f32 v66, v68, v69
  v_mfma_f32_16x16x32_bf16 v[84:87], v[240:243], a[160:163], v[84:87]
  v_exp_f32 v70, v70
  v_mfma_f32_16x16x32_bf16 v[92:95], v[240:243], a[176:179], v[92:95]
  buffer_load_dwordx4 v4, s[16:19], s31 offen offset:1024 nt lds
  v_mfma_f32_16x16x32_bf16 v[100:103], v[240:243], a[192:195], v[100:103]
  v_exp_f32 v71, v71
  v_mfma_f32_16x16x32_bf16 v[108:111], v[240:243], a[208:211], v[108:111]
  s_waitcnt lgkmcnt(0)
  v_cvt_pk_bf16_f32 v67, v70, v71
  v_mfma_f32_16x16x32_bf16 v[132:135], a[100:103], v[32:35], v[132:135]
  v_exp_f32 v72, v72
  v_add_u32 v28, 0, v17
  v_mfma_f32_16x16x32_bf16 v[148:151], a[100:103], v[40:43], v[148:151]
  s_add_u32 s40, s20, s5
  s_addc_u32 s41, s21, 0
  v_mul_u32_u24 v248, 171, v28
  v_mfma_f32_16x16x32_bf16 v[164:167], a[100:103], v[48:51], v[164:167]
  s_cmp_lg_u32 s9, 0
  s_cselect_b32 s42, 0x60000, 0
  v_exp_f32 v73, v73
  v_lshrrev_b32 v248, 10, v248
  v_mfma_f32_16x16x32_bf16 v[180:183], a[100:103], v[56:59], v[180:183]
  s_mov_b32 s43, 0x20000
  ds_read_b128 v[212:215], v5 offset:32768
  v_cvt_pk_bf16_f32 v72, v72, v73
  v_mfma_f32_16x16x32_bf16 v[196:199], a[100:103], v[64:67], v[196:199]
  s_mul_i32 s55, s24, 0xc00
  v_exp_f32 v74, v74
  v_mul_u32_u24 v249, 6, v248
  v_mfma_f32_16x16x32_bf16 v[136:139], a[104:107], v[32:35], v[136:139]
  s_lshl_b32 s35, s24, 15
  v_add_u32 v1, s35, v30
  v_sub_u32 v28, v28, v249
  v_mfma_f32_16x16x32_bf16 v[152:155], a[104:107], v[40:43], v[152:155]
  s_movk_i32 s48, 4096
  v_exp_f32 v75, v75
  v_lshlrev_b32 v28, 4, v28
  v_mfma_f32_16x16x32_bf16 v[168:171], a[104:107], v[48:51], v[168:171]
  s_movk_i32 s49, 8192
  ds_read_b128 v[216:219], v6 offset:32768
  v_cvt_pk_bf16_f32 v73, v74, v75
  v_mfma_f32_16x16x32_bf16 v[184:187], a[104:107], v[56:59], v[184:187]
  s_movk_i32 s50, 12288
  v_exp_f32 v80, v80
  v_mul_u32_u24 v248, 1152, v248
  v_mfma_f32_16x16x32_bf16 v[200:203], a[104:107], v[64:67], v[200:203]
  s_movk_i32 s51, 16384
  v_add_u32 v2, 0x20000, v1
  v_add_u32 v3, 0x40000, v1
  v_mfma_f32_16x16x32_bf16 v[140:143], a[108:111], v[32:35], v[140:143]
  s_movk_i32 s52, 20480
  v_exp_f32 v81, v81
  v_add_u32 v28, v28, v248
  v_mfma_f32_16x16x32_bf16 v[156:159], a[108:111], v[40:43], v[156:159]
  s_movk_i32 s53, 24576
  ds_read_b128 v[220:223], v7 offset:32768
  v_cvt_pk_bf16_f32 v80, v80, v81
  v_mfma_f32_16x16x32_bf16 v[172:175], a[108:111], v[48:51], v[172:175]
  s_movk_i32 s54, 28672
  v_exp_f32 v82, v82
  v_add_u32 v29, 64, v17
  v_mfma_f32_16x16x32_bf16 v[188:191], a[108:111], v[56:59], v[188:191]
  v_add_u32 v4, 0x60000, v1
  v_mov_b32 v253, 0x21400
  v_mfma_f32_16x16x32_bf16 v[204:207], a[108:111], v[64:67], v[204:207]
  v_exp_f32 v83, v83
  v_mul_u32_u24 v248, 171, v29
  v_mfma_f32_16x16x32_bf16 v[144:147], a[112:115], v[32:35], v[144:147]
  ds_read_b128 v[224:227], v8 offset:32768
  v_cvt_pk_bf16_f32 v81, v82, v83
  v_mfma_f32_16x16x32_bf16 v[160:163], a[112:115], v[40:43], v[160:163]
  v_exp_f32 v88, v88
  v_lshrrev_b32 v248, 10, v248
  v_mfma_f32_16x16x32_bf16 v[176:179], a[112:115], v[48:51], v[176:179]
  v_mul_u32_u24 v249, 6, v248
  v_mfma_f32_16x16x32_bf16 v[192:195], a[112:115], v[56:59], v[192:195]
  v_exp_f32 v89, v89
  v_sub_u32 v29, v29, v249
  v_mfma_f32_16x16x32_bf16 v[208:211], a[112:115], v[64:67], v[208:211]
  ds_read_b128 v[228:231], v5 offset:36864
  v_cvt_pk_bf16_f32 v88, v88, v89
  v_mfma_f32_16x16x32_bf16 a[0:3], a[116:119], v[32:35], a[0:3]
  s_lshl_b32 s35, s24, 2
  v_exp_f32 v90, v90
  v_lshlrev_b32 v29, 4, v29
  v_mfma_f32_16x16x32_bf16 a[16:19], a[116:119], v[40:43], a[16:19]
  s_add_u32 s35, s35, 0x21400
  v_mov_b32 v252, s35
  v_mul_u32_u24 v248, 1152, v248
  v_mfma_f32_16x16x32_bf16 a[32:35], a[116:119], v[48:51], a[32:35]
  v_exp_f32 v91, v91
  v_add_u32 v29, v29, v248
  v_mfma_f32_16x16x32_bf16 a[48:51], a[116:119], v[56:59], a[48:51]
  ds_read_b128 v[232:235], v6 offset:36864
  v_cvt_pk_bf16_f32 v89, v90, v91
  v_mfma_f32_16x16x32_bf16 a[64:67], a[116:119], v[64:67], a[64:67]
  s_mul_i32 s35, s24, 20480
  v_exp_f32 v96, v96
  v_subrev_u32 v29, 1024, v29
  v_mfma_f32_16x16x32_bf16 a[4:7], a[120:123], v[32:35], a[4:7]
  s_xor_b32 s36, s24, 1
  v_add_u32 v254, s35, v30
  v_add_u32 v31, 128, v17
  v_mfma_f32_16x16x32_bf16 a[20:23], a[120:123], v[40:43], a[20:23]
  v_exp_f32 v97, v97
  v_mul_u32_u24 v248, 171, v31
  v_mfma_f32_16x16x32_bf16 a[36:39], a[120:123], v[48:51], a[36:39]
  ds_read_b128 v[236:239], v7 offset:36864
  v_cvt_pk_bf16_f32 v96, v96, v97
  v_mfma_f32_16x16x32_bf16 a[52:55], a[120:123], v[56:59], a[52:55]
  s_mul_i32 s36, s36, 20480
  v_exp_f32 v98, v98
  v_lshrrev_b32 v248, 10, v248
  v_mfma_f32_16x16x32_bf16 a[68:71], a[120:123], v[64:67], a[68:71]
  v_add_u32 v255, s36, v30
  v_mul_u32_u24 v249, 6, v248
  v_mfma_f32_16x16x32_bf16 a[8:11], a[124:127], v[32:35], a[8:11]
  s_mul_i32 s10, s24, 1179648
  v_exp_f32 v99, v99
  v_sub_u32 v31, v31, v249
  v_mfma_f32_16x16x32_bf16 a[24:27], a[124:127], v[40:43], a[24:27]
  s_add_u32 s10, s10, s6
  ds_read_b128 v[240:243], v8 offset:36864
  v_cvt_pk_bf16_f32 v97, v98, v99
  v_mfma_f32_16x16x32_bf16 a[40:43], a[124:127], v[48:51], a[40:43]
  s_add_u32 s92, s92, s10
  s_addc_u32 s93, s93, 0
  v_exp_f32 v104, v104
  v_lshlrev_b32 v31, 4, v31
  v_mfma_f32_16x16x32_bf16 a[56:59], a[124:127], v[56:59], a[56:59]
  s_sub_u32 s94, 4718592, s10
  v_mul_u32_u24 v248, 1152, v248
  v_mfma_f32_16x16x32_bf16 a[72:75], a[124:127], v[64:67], a[72:75]
  s_cmp_lg_u32 s9, 0
  s_cselect_b32 s94, s94, 0
  v_exp_f32 v105, v105
  v_add_u32 v31, v31, v248
  v_mfma_f32_16x16x32_bf16 a[12:15], a[128:131], v[32:35], a[12:15]
  s_mov_b32 s95, 0x20000
  v_cvt_pk_bf16_f32 v104, v104, v105
  v_subrev_u32 v31, 2048, v31
  v_mfma_f32_16x16x32_bf16 a[28:31], a[128:131], v[40:43], a[28:31]
  v_exp_f32 v106, v106
  v_mfma_f32_16x16x32_bf16 a[44:47], a[128:131], v[48:51], a[44:47]
  v_mfma_f32_16x16x32_bf16 a[60:63], a[128:131], v[56:59], a[60:63]
  v_exp_f32 v107, v107
  v_mfma_f32_16x16x32_bf16 a[76:79], a[128:131], v[64:67], a[76:79]
  v_cvt_pk_bf16_f32 v105, v106, v107
  v_mfma_f32_16x16x32_bf16 a[80:83], v[244:247], v[32:35], a[80:83]
  v_mfma_f32_16x16x32_bf16 a[84:87], v[244:247], v[40:43], a[84:87]
  v_mfma_f32_16x16x32_bf16 a[88:91], v[244:247], v[48:51], a[88:91]
  v_mfma_f32_16x16x32_bf16 a[92:95], v[244:247], v[56:59], a[92:95]
  v_mfma_f32_16x16x32_bf16 a[96:99], v[244:247], v[64:67], a[96:99]
  s_waitcnt vmcnt(12) lgkmcnt(0)
  s_barrier
  v_mfma_f32_16x16x32_bf16 v[32:35], v[212:215], a[132:135], v[112:115]
  v_exp_f32 v76, v76
  v_mfma_f32_16x16x32_bf16 v[40:43], v[212:215], a[148:151], v[116:119]
  ds_read_b64_tr_b16 a[100:101], v9 offset:16384
  ds_read_b64_tr_b16 a[102:103], v9 offset:20480
  v_mfma_f32_16x16x32_bf16 v[48:51], v[212:215], a[164:167], v[120:123]
  v_exp_f32 v77, v77
  v_mfma_f32_16x16x32_bf16 v[56:59], v[212:215], a[180:183], v[124:127]
  ds_read_b64_tr_b16 a[104:105], v10 offset:16384
  v_cvt_pk_bf16_f32 v74, v76, v77
  v_mfma_f32_16x16x32_bf16 v[64:67], v[212:215], a[196:199], v[128:131]
  v_exp_f32 v78, v78
  v_mfma_f32_16x16x32_bf16 v[32:35], v[216:219], a[136:139], v[32:35]
  ds_read_b64_tr_b16 a[106:107], v10 offset:20480
  ds_read_b64_tr_b16 a[108:109], v11 offset:16384
  v_mfma_f32_16x16x32_bf16 v[40:43], v[216:219], a[152:155], v[40:43]
  v_exp_f32 v79, v79
  v_mfma_f32_16x16x32_bf16 v[48:51], v[216:219], a[168:171], v[48:51]
  ds_read_b64_tr_b16 a[110:111], v11 offset:20480
  v_cvt_pk_bf16_f32 v75, v78, v79
  v_mfma_f32_16x16x32_bf16 v[56:59], v[216:219], a[184:187], v[56:59]
  v_exp_f32 v84, v84
  v_mfma_f32_16x16x32_bf16 v[64:67], v[216:219], a[200:203], v[64:67]
  ds_read_b64_tr_b16 a[112:113], v12 offset:16384
  ds_read_b64_tr_b16 a[114:115], v12 offset:20480
  v_mfma_f32_16x16x32_bf16 v[32:35], v[220:223], a[140:143], v[32:35]
  v_exp_f32 v85, v85
  v_mfma_f32_16x16x32_bf16 v[40:43], v[220:223], a[156:159], v[40:43]
  ds_read_b64_tr_b16 a[116:117], v13 offset:16384
  v_cvt_pk_bf16_f32 v82, v84, v85
  v_mfma_f32_16x16x32_bf16 v[48:51], v[220:223], a[172:175], v[48:51]
  v_exp_f32 v86, v86
  v_mfma_f32_16x16x32_bf16 v[56:59], v[220:223], a[188:191], v[56:59]
  ds_read_b64_tr_b16 a[118:119], v13 offset:20480
  ds_read_b64_tr_b16 a[120:121], v14 offset:16384
  v_mfma_f32_16x16x32_bf16 v[64:67], v[220:223], a[204:207], v[64:67]
  v_exp_f32 v87, v87
  v_mfma_f32_16x16x32_bf16 v[32:35], v[224:227], a[144:147], v[32:35]
  ds_read_b64_tr_b16 a[122:123], v14 offset:20480
  v_cvt_pk_bf16_f32 v83, v86, v87
  v_mfma_f32_16x16x32_bf16 v[40:43], v[224:227], a[160:163], v[40:43]
  v_exp_f32 v92, v92
  v_mfma_f32_16x16x32_bf16 v[48:51], v[224:227], a[176:179], v[48:51]
  ds_read_b64_tr_b16 a[124:125], v15 offset:16384
  ds_read_b64_tr_b16 a[126:127], v15 offset:20480
  v_mfma_f32_16x16x32_bf16 v[56:59], v[224:227], a[192:195], v[56:59]
  v_exp_f32 v93, v93
  v_mfma_f32_16x16x32_bf16 v[64:67], v[224:227], a[208:211], v[64:67]
  ds_read_b64_tr_b16 a[128:129], v16 offset:16384
  v_cvt_pk_bf16_f32 v90, v92, v93
  v_mfma_f32_16x16x32_bf16 v[36:39], v[228:231], a[132:135], v[112:115]
  v_exp_f32 v94, v94
  v_mfma_f32_16x16x32_bf16 v[44:47], v[228:231], a[148:151], v[116:119]
  ds_read_b64_tr_b16 a[130:131], v16 offset:20480
  v_mfma_f32_16x16x32_bf16 v[52:55], v[228:231], a[164:167], v[120:123]
  v_exp_f32 v95, v95
  v_mfma_f32_16x16x32_bf16 v[60:63], v[228:231], a[180:183], v[124:127]
  v_cvt_pk_bf16_f32 v91, v94, v95
  v_mfma_f32_16x16x32_bf16 v[68:71], v[228:231], a[196:199], v[128:131]
  v_exp_f32 v100, v100
  v_mfma_f32_16x16x32_bf16 v[36:39], v[232:235], a[136:139], v[36:39]
  buffer_load_dwordx4 a[216:219], v1, s[40:43], s48 offen offset:3072 sc1
  v_mfma_f32_16x16x32_bf16 v[44:47], v[232:235], a[152:155], v[44:47]
  v_exp_f32 v101, v101
  v_mfma_f32_16x16x32_bf16 v[52:55], v[232:235], a[168:171], v[52:55]
  v_cvt_pk_bf16_f32 v98, v100, v101
  v_mfma_f32_16x16x32_bf16 v[60:63], v[232:235], a[184:187], v[60:63]
  v_exp_f32 v102, v102
  v_mfma_f32_16x16x32_bf16 v[68:71], v[232:235], a[200:203], v[68:71]
  buffer_load_dwordx4 a[220:223], v2, s[40:43], s48 offen offset:3072 sc1
  v_mfma_f32_16x16x32_bf16 v[36:39], v[236:239], a[140:143], v[36:39]
  v_exp_f32 v103, v103
  v_mfma_f32_16x16x32_bf16 v[44:47], v[236:239], a[156:159], v[44:47]
  v_cvt_pk_bf16_f32 v99, v102, v103
  v_mfma_f32_16x16x32_bf16 v[52:55], v[236:239], a[172:175], v[52:55]
  v_exp_f32 v108, v108
  v_mfma_f32_16x16x32_bf16 v[60:63], v[236:239], a[188:191], v[60:63]
  buffer_load_dwordx4 a[224:227], v3, s[40:43], s48 offen offset:3072 sc1
  v_mfma_f32_16x16x32_bf16 v[68:71], v[236:239], a[204:207], v[68:71]
  v_exp_f32 v109, v109
  v_mfma_f32_16x16x32_bf16 v[36:39], v[240:243], a[144:147], v[36:39]
  v_cvt_pk_bf16_f32 v106, v108, v109
  v_mfma_f32_16x16x32_bf16 v[44:47], v[240:243], a[160:163], v[44:47]
  v_exp_f32 v110, v110
  v_mfma_f32_16x16x32_bf16 v[52:55], v[240:243], a[176:179], v[52:55]
  buffer_load_dwordx4 a[228:231], v1, s[40:43], s49 offen sc1
  v_mfma_f32_16x16x32_bf16 v[60:63], v[240:243], a[192:195], v[60:63]
  v_exp_f32 v111, v111
  v_mfma_f32_16x16x32_bf16 v[68:71], v[240:243], a[208:211], v[68:71]
  s_waitcnt lgkmcnt(0)
  v_cvt_pk_bf16_f32 v107, v110, v111
  v_mfma_f32_16x16x32_bf16 v[132:135], a[100:103], v[72:75], v[132:135]
  v_exp_f32 v32, v32
  v_mfma_f32_16x16x32_bf16 v[148:151], a[100:103], v[80:83], v[148:151]
  buffer_load_dwordx4 a[232:235], v2, s[40:43], s49 offen sc1
  v_mfma_f32_16x16x32_bf16 v[164:167], a[100:103], v[88:91], v[164:167]
  v_exp_f32 v33, v33
  v_mfma_f32_16x16x32_bf16 v[180:183], a[100:103], v[96:99], v[180:183]
  ds_read_b128 v[212:215], v5 offset:49152
  v_cvt_pk_bf16_f32 v32, v32, v33
  v_mfma_f32_16x16x32_bf16 v[196:199], a[100:103], v[104:107], v[196:199]
  v_exp_f32 v34, v34
  v_mfma_f32_16x16x32_bf16 v[136:139], a[104:107], v[72:75], v[136:139]
  buffer_load_dwordx4 a[236:239], v3, s[40:43], s49 offen sc1
  v_mfma_f32_16x16x32_bf16 v[152:155], a[104:107], v[80:83], v[152:155]
  v_exp_f32 v35, v35
  v_mfma_f32_16x16x32_bf16 v[168:171], a[104:107], v[88:91], v[168:171]
  ds_read_b128 v[216:219], v6 offset:49152
  v_cvt_pk_bf16_f32 v33, v34, v35
  v_mfma_f32_16x16x32_bf16 v[184:187], a[104:107], v[96:99], v[184:187]
  v_exp_f32 v40, v40
  v_mfma_f32_16x16x32_bf16 v[200:203], a[104:107], v[104:107], v[200:203]
  buffer_load_dwordx4 a[240:243], v1, s[40:43], s49 offen offset:1024 sc1
  v_mfma_f32_16x16x32_bf16 v[140:143], a[108:111], v[72:75], v[140:143]
  v_exp_f32 v41, v41
  v_mfma_f32_16x16x32_bf16 v[156:159], a[108:111], v[80:83], v[156:159]
  ds_read_b128 v[220:223], v7 offset:49152
  v_cvt_pk_bf16_f32 v40, v40, v41
  v_mfma_f32_16x16x32_bf16 v[172:175], a[108:111], v[88:91], v[172:175]
  v_exp_f32 v42, v42
  v_mfma_f32_16x16x32_bf16 v[188:191], a[108:111], v[96:99], v[188:191]
  buffer_load_dwordx4 a[244:247], v2, s[40:43], s49 offen offset:1024 sc1
  v_mfma_f32_16x16x32_bf16 v[204:207], a[108:111], v[104:107], v[204:207]
  v_exp_f32 v43, v43
  v_mfma_f32_16x16x32_bf16 v[144:147], a[112:115], v[72:75], v[144:147]
  ds_read_b128 v[224:227], v8 offset:49152
  v_cvt_pk_bf16_f32 v41, v42, v43
  v_mfma_f32_16x16x32_bf16 v[160:163], a[112:115], v[80:83], v[160:163]
  v_exp_f32 v48, v48
  v_mfma_f32_16x16x32_bf16 v[176:179], a[112:115], v[88:91], v[176:179]
  buffer_load_dwordx4 a[248:251], v3, s[40:43], s49 offen offset:1024 sc1
  v_mfma_f32_16x16x32_bf16 v[192:195], a[112:115], v[96:99], v[192:195]
  v_exp_f32 v49, v49
  v_mfma_f32_16x16x32_bf16 v[208:211], a[112:115], v[104:107], v[208:211]
  s_mov_b32 s36, 774144
  ds_read_b128 v[228:231], v5 offset:53248
  v_cvt_pk_bf16_f32 v48, v48, v49
  v_mfma_f32_16x16x32_bf16 a[0:3], a[116:119], v[72:75], a[0:3]
  s_add_u32 m0, s55, 0x22000
  v_exp_f32 v50, v50
  v_mfma_f32_16x16x32_bf16 a[16:19], a[116:119], v[80:83], a[16:19]
  buffer_load_dwordx4 v28, s[92:95], s36 offen lds
  v_mfma_f32_16x16x32_bf16 a[32:35], a[116:119], v[88:91], a[32:35]
  v_exp_f32 v51, v51
  v_mfma_f32_16x16x32_bf16 a[48:51], a[116:119], v[96:99], a[48:51]
  ds_read_b128 v[232:235], v6 offset:53248
  v_cvt_pk_bf16_f32 v49, v50, v51
  v_mfma_f32_16x16x32_bf16 a[64:67], a[116:119], v[104:107], a[64:67]
  v_exp_f32 v56, v56
  v_mfma_f32_16x16x32_bf16 a[4:7], a[120:123], v[72:75], a[4:7]
  buffer_load_dwordx4 v29, s[92:95], s36 offen offset:1024 lds
  v_mfma_f32_16x16x32_bf16 a[20:23], a[120:123], v[80:83], a[20:23]
  v_exp_f32 v57, v57
  v_mfma_f32_16x16x32_bf16 a[36:39], a[120:123], v[88:91], a[36:39]
  ds_read_b128 v[236:239], v7 offset:53248
  v_cvt_pk_bf16_f32 v56, v56, v57
  v_mfma_f32_16x16x32_bf16 a[52:55], a[120:123], v[96:99], a[52:55]
  v_exp_f32 v58, v58
  v_mfma_f32_16x16x32_bf16 a[68:71], a[120:123], v[104:107], a[68:71]
  buffer_load_dwordx4 v31, s[92:95], s36 offen offset:2048 lds
  v_mfma_f32_16x16x32_bf16 a[8:11], a[124:127], v[72:75], a[8:11]
  v_exp_f32 v59, v59
  v_mfma_f32_16x16x32_bf16 a[24:27], a[124:127], v[80:83], a[24:27]
  s_mov_b32 s36, 811008
  ds_read_b128 v[240:243], v8 offset:53248
  v_cvt_pk_bf16_f32 v57, v58, v59
  v_mfma_f32_16x16x32_bf16 a[40:43], a[124:127], v[88:91], a[40:43]
  s_add_u32 m0, s55, 0x25000
  v_exp_f32 v64, v64
  v_mfma_f32_16x16x32_bf16 a[56:59], a[124:127], v[96:99], a[56:59]
  buffer_load_dwordx4 v28, s[92:95], s36 offen lds
  v_mfma_f32_16x16x32_bf16 a[72:75], a[124:127], v[104:107], a[72:75]
  v_exp_f32 v65, v65
  v_mfma_f32_16x16x32_bf16 a[12:15], a[128:131], v[72:75], a[12:15]
  v_cvt_pk_bf16_f32 v64, v64, v65
  v_mfma_f32_16x16x32_bf16 a[28:31], a[128:131], v[80:83], a[28:31]
  v_exp_f32 v66, v66
  v_mfma_f32_16x16x32_bf16 a[44:47], a[128:131], v[88:91], a[44:47]
  buffer_load_dwordx4 v29, s[92:95], s36 offen offset:1024 lds
  v_mfma_f32_16x16x32_bf16 a[60:63], a[128:131], v[96:99], a[60:63]
  v_exp_f32 v67, v67
  v_mfma_f32_16x16x32_bf16 a[76:79], a[128:131], v[104:107], a[76:79]
  v_cvt_pk_bf16_f32 v65, v66, v67
  v_mfma_f32_16x16x32_bf16 a[80:83], v[244:247], v[72:75], a[80:83]
  v_mfma_f32_16x16x32_bf16 a[84:87], v[244:247], v[80:83], a[84:87]
  buffer_load_dwordx4 v31, s[92:95], s36 offen offset:2048 lds
  v_mfma_f32_16x16x32_bf16 a[88:91], v[244:247], v[88:91], a[88:91]
  v_mfma_f32_16x16x32_bf16 a[92:95], v[244:247], v[96:99], a[92:95]
  v_mfma_f32_16x16x32_bf16 a[96:99], v[244:247], v[104:107], a[96:99]
  s_waitcnt vmcnt(19) lgkmcnt(0)
  s_barrier
  v_mfma_f32_16x16x32_bf16 v[72:75], v[212:215], a[132:135], v[112:115]
  v_exp_f32 v36, v36
  v_mfma_f32_16x16x32_bf16 v[80:83], v[212:215], a[148:151], v[116:119]
  ds_read_b64_tr_b16 a[100:101], v9 offset:32768
  ds_read_b64_tr_b16 a[102:103], v9 offset:36864
  v_mfma_f32_16x16x32_bf16 v[88:91], v[212:215], a[164:167], v[120:123]
  v_exp_f32 v37, v37
  v_mfma_f32_16x16x32_bf16 v[96:99], v[212:215], a[180:183], v[124:127]
  ds_read_b64_tr_b16 a[104:105], v10 offset:32768
  v_cvt_pk_bf16_f32 v34, v36, v37
  v_mfma_f32_16x16x32_bf16 v[104:107], v[212:215], a[196:199], v[128:131]
  v_exp_f32 v38, v38
  v_mfma_f32_16x16x32_bf16 v[72:75], v[216:219], a[136:139], v[72:75]
  ds_read_b64_tr_b16 a[106:107], v10 offset:36864
  ds_read_b64_tr_b16 a[108:109], v11 offset:32768
  v_mfma_f32_16x16x32_bf16 v[80:83], v[216:219], a[152:155], v[80:83]
  v_exp_f32 v39, v39
  v_mfma_f32_16x16x32_bf16 v[88:91], v[216:219], a[168:171], v[88:91]
  ds_read_b64_tr_b16 a[110:111], v11 offset:36864
  v_cvt_pk_bf16_f32 v35, v38, v39
  v_mfma_f32_16x16x32_bf16 v[96:99], v[216:219], a[184:187], v[96:99]
  v_exp_f32 v44, v44
  v_mfma_f32_16x16x32_bf16 v[104:107], v[216:219], a[200:203], v[104:107]
  ds_read_b64_tr_b16 a[112:113], v12 offset:32768
  ds_read_b64_tr_b16 a[114:115], v12 offset:36864
  v_mfma_f32_16x16x32_bf16 v[72:75], v[220:223], a[140:143], v[72:75]
  v_exp_f32 v45, v45
  v_mfma_f32_16x16x32_bf16 v[80:83], v[220:223], a[156:159], v[80:83]
  ds_read_b64_tr_b16 a[116:117], v13 offset:32768
  v_cvt_pk_bf16_f32 v42, v44, v45
  v_mfma_f32_16x16x32_bf16 v[88:91], v[220:223], a[172:175], v[88:91]
  v_exp_f32 v46, v46
  v_mfma_f32_16x16x32_bf16 v[96:99], v[220:223], a[188:191], v[96:99]
  ds_read_b64_tr_b16 a[118:119], v13 offset:36864
  ds_read_b64_tr_b16 a[120:121], v14 offset:32768
  v_mfma_f32_16x16x32_bf16 v[104:107], v[220:223], a[204:207], v[104:107]
  v_exp_f32 v47, v47
  v_mfma_f32_16x16x32_bf16 v[72:75], v[224:227], a[144:147], v[72:75]
  ds_read_b64_tr_b16 a[122:123], v14 offset:36864
  v_cvt_pk_bf16_f32 v43, v46, v47
  v_mfma_f32_16x16x32_bf16 v[80:83], v[224:227], a[160:163], v[80:83]
  v_exp_f32 v52, v52
  v_mfma_f32_16x16x32_bf16 v[88:91], v[224:227], a[176:179], v[88:91]
  ds_read_b64_tr_b16 a[124:125], v15 offset:32768
  ds_read_b64_tr_b16 a[126:127], v15 offset:36864
  v_mfma_f32_16x16x32_bf16 v[96:99], v[224:227], a[192:195], v[96:99]
  v_exp_f32 v53, v53
  v_mfma_f32_16x16x32_bf16 v[104:107], v[224:227], a[208:211], v[104:107]
  ds_read_b64_tr_b16 a[128:129], v16 offset:32768
  v_cvt_pk_bf16_f32 v50, v52, v53
  v_mfma_f32_16x16x32_bf16 v[76:79], v[228:231], a[132:135], v[112:115]
  v_exp_f32 v54, v54
  v_mfma_f32_16x16x32_bf16 v[84:87], v[228:231], a[148:151], v[116:119]
  ds_read_b64_tr_b16 a[130:131], v16 offset:36864
  v_mfma_f32_16x16x32_bf16 v[92:95], v[228:231], a[164:167], v[120:123]
  v_exp_f32 v55, v55
  v_mfma_f32_16x16x32_bf16 v[100:103], v[228:231], a[180:183], v[124:127]
  s_mov_b32 s36, 847872
  v_cvt_pk_bf16_f32 v51, v54, v55
  v_mfma_f32_16x16x32_bf16 v[108:111], v[228:231], a[196:199], v[128:131]
  s_add_u32 m0, s55, 0x14000
  v_exp_f32 v60, v60
  v_mfma_f32_16x16x32_bf16 v[76:79], v[232:235], a[136:139], v[76:79]
  buffer_load_dwordx4 v28, s[92:95], s36 offen lds
  v_mfma_f32_16x16x32_bf16 v[84:87], v[232:235], a[152:155], v[84:87]
  v_exp_f32 v61, v61
  v_mfma_f32_16x16x32_bf16 v[92:95], v[232:235], a[168:171], v[92:95]
  v_cvt_pk_bf16_f32 v58, v60, v61
  v_mfma_f32_16x16x32_bf16 v[100:103], v[232:235], a[184:187], v[100:103]
  v_exp_f32 v62, v62
  v_mfma_f32_16x16x32_bf16 v[108:111], v[232:235], a[200:203], v[108:111]
  buffer_load_dwordx4 v29, s[92:95], s36 offen offset:1024 lds
  v_mfma_f32_16x16x32_bf16 v[76:79], v[236:239], a[140:143], v[76:79]
  v_exp_f32 v63, v63
  v_mfma_f32_16x16x32_bf16 v[84:87], v[236:239], a[156:159], v[84:87]
  v_cvt_pk_bf16_f32 v59, v62, v63
  v_mfma_f32_16x16x32_bf16 v[92:95], v[236:239], a[172:175], v[92:95]
  v_exp_f32 v68, v68
  v_mfma_f32_16x16x32_bf16 v[100:103], v[236:239], a[188:191], v[100:103]
  buffer_load_dwordx4 v31, s[92:95], s36 offen offset:2048 lds
  v_mfma_f32_16x16x32_bf16 v[108:111], v[236:239], a[204:207], v[108:111]
  v_exp_f32 v69, v69
  v_mfma_f32_16x16x32_bf16 v[76:79], v[240:243], a[144:147], v[76:79]
  v_cvt_pk_bf16_f32 v66, v68, v69
  v_mfma_f32_16x16x32_bf16 v[84:87], v[240:243], a[160:163], v[84:87]
  v_exp_f32 v70, v70
  v_mfma_f32_16x16x32_bf16 v[92:95], v[240:243], a[176:179], v[92:95]
  v_mfma_f32_16x16x32_bf16 v[100:103], v[240:243], a[192:195], v[100:103]
  v_exp_f32 v71, v71
  v_mfma_f32_16x16x32_bf16 v[108:111], v[240:243], a[208:211], v[108:111]
  s_waitcnt lgkmcnt(0)
  v_cvt_pk_bf16_f32 v67, v70, v71
  v_mfma_f32_16x16x32_bf16 v[132:135], a[100:103], v[32:35], v[132:135]
  v_exp_f32 v72, v72
  v_mfma_f32_16x16x32_bf16 v[148:151], a[100:103], v[40:43], v[148:151]
  buffer_load_dwordx4 a[132:135], v1, s[40:43], 0 offen sc1
  v_mfma_f32_16x16x32_bf16 v[164:167], a[100:103], v[48:51], v[164:167]
  s_mul_i32 s35, s24, 1280
  v_exp_f32 v73, v73
  v_mfma_f32_16x16x32_bf16 v[180:183], a[100:103], v[56:59], v[180:183]
  s_add_u32 s35, s35, 0x20000
  v_cvt_pk_bf16_f32 v72, v72, v73
  v_lshlrev_b32 v8, 2, v17
  v_mfma_f32_16x16x32_bf16 v[196:199], a[100:103], v[64:67], v[196:199]
  s_xor_b32 s36, s24, 1
  v_exp_f32 v74, v74
  v_mfma_f32_16x16x32_bf16 v[136:139], a[104:107], v[32:35], v[136:139]
  buffer_load_dwordx4 a[136:139], v2, s[40:43], 0 offen sc1
  v_mfma_f32_16x16x32_bf16 v[152:155], a[104:107], v[40:43], v[152:155]
  s_mul_i32 s36, s36, 1280
  v_exp_f32 v75, v75
  v_mfma_f32_16x16x32_bf16 v[168:171], a[104:107], v[48:51], v[168:171]
  s_add_u32 s36, s36, 0x20000
  v_cvt_pk_bf16_f32 v73, v74, v75
  v_add_u32 v7, s35, v8
  v_mfma_f32_16x16x32_bf16 v[184:187], a[104:107], v[56:59], v[184:187]
  v_exp_f32 v80, v80
  v_mfma_f32_16x16x32_bf16 v[200:203], a[104:107], v[64:67], v[200:203]
  buffer_load_dwordx4 a[140:143], v3, s[40:43], 0 offen sc1
  v_mfma_f32_16x16x32_bf16 v[140:143], a[108:111], v[32:35], v[140:143]
  v_exp_f32 v81, v81
  v_mfma_f32_16x16x32_bf16 v[156:159], a[108:111], v[40:43], v[156:159]
  v_cvt_pk_bf16_f32 v80, v80, v81
  v_add_u32 v8, s36, v8
  v_mfma_f32_16x16x32_bf16 v[172:175], a[108:111], v[48:51], v[172:175]
  v_exp_f32 v82, v82
  v_mfma_f32_16x16x32_bf16 v[188:191], a[108:111], v[56:59], v[188:191]
  buffer_load_dwordx4 a[144:147], v1, s[40:43], 0 offen offset:1024 sc1
  v_mfma_f32_16x16x32_bf16 v[204:207], a[108:111], v[64:67], v[204:207]
  v_exp_f32 v83, v83
  v_mfma_f32_16x16x32_bf16 v[144:147], a[112:115], v[32:35], v[144:147]
  v_cvt_pk_bf16_f32 v81, v82, v83
  v_mfma_f32_16x16x32_bf16 v[160:163], a[112:115], v[40:43], v[160:163]
  v_exp_f32 v88, v88
  v_mfma_f32_16x16x32_bf16 v[176:179], a[112:115], v[48:51], v[176:179]
  buffer_load_dwordx4 a[148:151], v2, s[40:43], 0 offen offset:1024 sc1
  v_mfma_f32_16x16x32_bf16 v[192:195], a[112:115], v[56:59], v[192:195]
  v_exp_f32 v89, v89
  v_mfma_f32_16x16x32_bf16 v[208:211], a[112:115], v[64:67], v[208:211]
  v_cvt_pk_bf16_f32 v88, v88, v89
  v_mfma_f32_16x16x32_bf16 a[0:3], a[116:119], v[32:35], a[0:3]
  v_exp_f32 v90, v90
  v_mfma_f32_16x16x32_bf16 a[16:19], a[116:119], v[40:43], a[16:19]
  buffer_load_dwordx4 a[152:155], v3, s[40:43], 0 offen offset:1024 sc1
  v_mfma_f32_16x16x32_bf16 a[32:35], a[116:119], v[48:51], a[32:35]
  v_exp_f32 v91, v91
  v_mfma_f32_16x16x32_bf16 a[48:51], a[116:119], v[56:59], a[48:51]
  v_cvt_pk_bf16_f32 v89, v90, v91
  v_mfma_f32_16x16x32_bf16 a[64:67], a[116:119], v[64:67], a[64:67]
  v_exp_f32 v96, v96
  v_mfma_f32_16x16x32_bf16 a[4:7], a[120:123], v[32:35], a[4:7]
  buffer_load_dwordx4 a[156:159], v1, s[40:43], 0 offen offset:2048 sc1
  v_mfma_f32_16x16x32_bf16 a[20:23], a[120:123], v[40:43], a[20:23]
  v_exp_f32 v97, v97
  v_mfma_f32_16x16x32_bf16 a[36:39], a[120:123], v[48:51], a[36:39]
  v_cvt_pk_bf16_f32 v96, v96, v97
  v_mfma_f32_16x16x32_bf16 a[52:55], a[120:123], v[56:59], a[52:55]
  v_exp_f32 v98, v98
  v_mfma_f32_16x16x32_bf16 a[68:71], a[120:123], v[64:67], a[68:71]
  buffer_load_dwordx4 a[160:163], v2, s[40:43], 0 offen offset:2048 sc1
  v_mfma_f32_16x16x32_bf16 a[8:11], a[124:127], v[32:35], a[8:11]
  v_exp_f32 v99, v99
  v_mfma_f32_16x16x32_bf16 a[24:27], a[124:127], v[40:43], a[24:27]
  v_cvt_pk_bf16_f32 v97, v98, v99
  v_mfma_f32_16x16x32_bf16 a[40:43], a[124:127], v[48:51], a[40:43]
  v_exp_f32 v104, v104
  v_mfma_f32_16x16x32_bf16 a[56:59], a[124:127], v[56:59], a[56:59]
  buffer_load_dwordx4 a[164:167], v3, s[40:43], 0 offen offset:2048 sc1
  v_mfma_f32_16x16x32_bf16 a[72:75], a[124:127], v[64:67], a[72:75]
  v_exp_f32 v105, v105
  v_mfma_f32_16x16x32_bf16 a[12:15], a[128:131], v[32:35], a[12:15]
  v_cvt_pk_bf16_f32 v104, v104, v105
  v_mfma_f32_16x16x32_bf16 a[28:31], a[128:131], v[40:43], a[28:31]
  v_exp_f32 v106, v106
  v_mfma_f32_16x16x32_bf16 a[44:47], a[128:131], v[48:51], a[44:47]
  buffer_load_dwordx4 a[168:171], v1, s[40:43], 0 offen offset:3072 sc1
  v_mfma_f32_16x16x32_bf16 a[60:63], a[128:131], v[56:59], a[60:63]
  v_exp_f32 v107, v107
  v_mfma_f32_16x16x32_bf16 a[76:79], a[128:131], v[64:67], a[76:79]
  v_cvt_pk_bf16_f32 v105, v106, v107
  v_mfma_f32_16x16x32_bf16 a[80:83], v[244:247], v[32:35], a[80:83]
  v_mfma_f32_16x16x32_bf16 a[84:87], v[244:247], v[40:43], a[84:87]
  buffer_load_dwordx4 a[172:175], v2, s[40:43], 0 offen offset:3072 sc1
  v_mfma_f32_16x16x32_bf16 a[88:91], v[244:247], v[48:51], a[88:91]
  v_mfma_f32_16x16x32_bf16 a[92:95], v[244:247], v[56:59], a[92:95]
  v_mfma_f32_16x16x32_bf16 a[96:99], v[244:247], v[64:67], a[96:99]
  s_waitcnt vmcnt(29) lgkmcnt(0)
  s_barrier
  ds_read_b64_tr_b16 a[116:117], v13 offset:49152
  ds_read_b64_tr_b16 a[118:119], v13 offset:53248
  ds_read_b64_tr_b16 a[120:121], v14 offset:49152
  ds_read_b64_tr_b16 a[122:123], v14 offset:53248
  ds_read_b64_tr_b16 a[124:125], v15 offset:49152
  ds_read_b64_tr_b16 a[126:127], v15 offset:53248
  ds_read_b64_tr_b16 a[128:129], v16 offset:49152
  ds_read_b64_tr_b16 a[130:131], v16 offset:53248
  ds_read_b64_tr_b16 a[100:101], v9 offset:49152
  ds_read_b64_tr_b16 a[102:103], v9 offset:53248
  ds_read_b64_tr_b16 a[104:105], v10 offset:49152
  ds_read_b64_tr_b16 a[106:107], v10 offset:53248
  ds_read_b64_tr_b16 a[108:109], v11 offset:49152
  ds_read_b64_tr_b16 a[110:111], v11 offset:53248
  ds_read_b64_tr_b16 a[112:113], v12 offset:49152
  ds_read_b64_tr_b16 a[114:115], v12 offset:53248
  v_exp_f32 v76, v76
  v_exp_f32 v77, v77
  v_exp_f32 v78, v78
  v_exp_f32 v79, v79
  v_cvt_pk_bf16_f32 v74, v76, v77
  v_cvt_pk_bf16_f32 v75, v78, v79
  s_nop 1
  v_mfma_f32_16x16x32_bf16 a[80:83], v[244:247], v[72:75], a[80:83]
  s_waitcnt lgkmcnt(14)
  v_exp_f32 v84, v84
  v_mfma_f32_16x16x32_bf16 a[0:3], a[116:119], v[72:75], a[0:3]
  s_waitcnt lgkmcnt(12)
  v_exp_f32 v85, v85
  v_mfma_f32_16x16x32_bf16 a[4:7], a[120:123], v[72:75], a[4:7]
  s_waitcnt lgkmcnt(10)
  v_exp_f32 v86, v86
  v_mfma_f32_16x16x32_bf16 a[8:11], a[124:127], v[72:75], a[8:11]
  s_waitcnt lgkmcnt(8)
  v_exp_f32 v87, v87
  v_mfma_f32_16x16x32_bf16 a[12:15], a[128:131], v[72:75], a[12:15]
  s_waitcnt lgkmcnt(6)
  v_cvt_pk_bf16_f32 v82, v84, v85
  buffer_load_dwordx4 a[176:179], v3, s[40:43], 0 offen offset:3072 sc1
  v_mfma_f32_16x16x32_bf16 v[132:135], a[100:103], v[72:75], v[132:135]
  s_waitcnt lgkmcnt(4)
  v_cvt_pk_bf16_f32 v83, v86, v87
  v_mfma_f32_16x16x32_bf16 v[136:139], a[104:107], v[72:75], v[136:139]
  s_waitcnt lgkmcnt(2)
  v_mfma_f32_16x16x32_bf16 v[140:143], a[108:111], v[72:75], v[140:143]
  s_waitcnt lgkmcnt(0)
  buffer_load_dwordx4 a[180:183], v1, s[40:43], s48 offen sc1
  v_mfma_f32_16x16x32_bf16 v[144:147], a[112:115], v[72:75], v[144:147]
  v_mfma_f32_16x16x32_bf16 a[84:87], v[244:247], v[80:83], a[84:87]
  v_exp_f32 v92, v92
  v_accvgpr_read_b32 v212, a80
  v_mfma_f32_16x16x32_bf16 a[16:19], a[116:119], v[80:83], a[16:19]
  v_exp_f32 v93, v93
  v_mfma_f32_16x16x32_bf16 a[20:23], a[120:123], v[80:83], a[20:23]
  v_exp_f32 v94, v94
  ds_write_b32 v7, v212 offset:0
  v_mfma_f32_16x16x32_bf16 a[24:27], a[124:127], v[80:83], a[24:27]
  v_exp_f32 v95, v95
  ds_write_b128 v254, a[0:3] offset:0
  v_mfma_f32_16x16x32_bf16 a[28:31], a[128:131], v[80:83], a[28:31]
  v_cvt_pk_bf16_f32 v90, v92, v93
  buffer_load_dwordx4 a[184:187], v2, s[40:43], s48 offen sc1
  v_mfma_f32_16x16x32_bf16 v[148:151], a[100:103], v[80:83], v[148:151]
  v_cvt_pk_bf16_f32 v91, v94, v95
  ds_write_b128 v254, a[4:7] offset:1024
  v_mfma_f32_16x16x32_bf16 v[152:155], a[104:107], v[80:83], v[152:155]
  ds_write_b128 v254, a[8:11] offset:2048
  v_mfma_f32_16x16x32_bf16 v[156:159], a[108:111], v[80:83], v[156:159]
  buffer_load_dwordx4 a[188:191], v3, s[40:43], s48 offen sc1
  v_mfma_f32_16x16x32_bf16 v[160:163], a[112:115], v[80:83], v[160:163]
  ds_write_b128 v254, a[12:15] offset:3072
  v_mfma_f32_16x16x32_bf16 a[88:91], v[244:247], v[88:91], a[88:91]
  v_exp_f32 v100, v100
  v_accvgpr_read_b32 v213, a84
  v_mfma_f32_16x16x32_bf16 a[32:35], a[116:119], v[88:91], a[32:35]
  v_exp_f32 v101, v101
  v_mfma_f32_16x16x32_bf16 a[36:39], a[120:123], v[88:91], a[36:39]
  v_exp_f32 v102, v102
  ds_write_b32 v7, v213 offset:256
  v_mfma_f32_16x16x32_bf16 a[40:43], a[124:127], v[88:91], a[40:43]
  v_exp_f32 v103, v103
  ds_write_b128 v254, a[16:19] offset:4096
  v_mfma_f32_16x16x32_bf16 a[44:47], a[128:131], v[88:91], a[44:47]
  v_cvt_pk_bf16_f32 v98, v100, v101
  buffer_load_dwordx4 a[192:195], v1, s[40:43], s48 offen offset:1024 sc1
  v_mfma_f32_16x16x32_bf16 v[164:167], a[100:103], v[88:91], v[164:167]
  v_cvt_pk_bf16_f32 v99, v102, v103
  ds_write_b128 v254, a[20:23] offset:5120
  v_mfma_f32_16x16x32_bf16 v[168:171], a[104:107], v[88:91], v[168:171]
  ds_write_b128 v254, a[24:27] offset:6144
  v_mfma_f32_16x16x32_bf16 v[172:175], a[108:111], v[88:91], v[172:175]
  buffer_load_dwordx4 a[196:199], v2, s[40:43], s48 offen offset:1024 sc1
  v_mfma_f32_16x16x32_bf16 v[176:179], a[112:115], v[88:91], v[176:179]
  ds_write_b128 v254, a[28:31] offset:7168
  v_mfma_f32_16x16x32_bf16 a[92:95], v[244:247], v[96:99], a[92:95]
  v_exp_f32 v108, v108
  v_accvgpr_read_b32 v214, a88
  v_mfma_f32_16x16x32_bf16 a[48:51], a[116:119], v[96:99], a[48:51]
  v_exp_f32 v109, v109
  v_mfma_f32_16x16x32_bf16 a[52:55], a[120:123], v[96:99], a[52:55]
  v_exp_f32 v110, v110
  ds_write_b32 v7, v214 offset:512
  v_mfma_f32_16x16x32_bf16 a[56:59], a[124:127], v[96:99], a[56:59]
  v_exp_f32 v111, v111
  ds_write_b128 v254, a[32:35] offset:8192
  v_mfma_f32_16x16x32_bf16 a[60:63], a[128:131], v[96:99], a[60:63]
  v_cvt_pk_bf16_f32 v106, v108, v109
  buffer_load_dwordx4 a[200:203], v3, s[40:43], s48 offen offset:1024 sc1
  v_mfma_f32_16x16x32_bf16 v[180:183], a[100:103], v[96:99], v[180:183]
  v_cvt_pk_bf16_f32 v107, v110, v111
  ds_write_b128 v254, a[36:39] offset:9216
  v_mfma_f32_16x16x32_bf16 v[184:187], a[104:107], v[96:99], v[184:187]
  ds_write_b128 v254, a[40:43] offset:10240
  v_mfma_f32_16x16x32_bf16 v[188:191], a[108:111], v[96:99], v[188:191]
  buffer_load_dwordx4 a[204:207], v1, s[40:43], s48 offen offset:2048 sc1
  v_mfma_f32_16x16x32_bf16 v[192:195], a[112:115], v[96:99], v[192:195]
  ds_write_b128 v254, a[44:47] offset:11264
  v_mfma_f32_16x16x32_bf16 a[96:99], v[244:247], v[104:107], a[96:99]
  v_accvgpr_read_b32 v215, a92
  v_mfma_f32_16x16x32_bf16 a[64:67], a[116:119], v[104:107], a[64:67]
  v_max3_f32 v248, v212, v213, v214
  v_min3_f32 v249, v212, v213, v214
  v_mfma_f32_16x16x32_bf16 a[68:71], a[120:123], v[104:107], a[68:71]
  ds_write_b32 v7, v215 offset:768
  v_mfma_f32_16x16x32_bf16 a[72:75], a[124:127], v[104:107], a[72:75]
  ds_write_b128 v254, a[48:51] offset:12288
  v_mfma_f32_16x16x32_bf16 a[76:79], a[128:131], v[104:107], a[76:79]
  buffer_load_dwordx4 a[208:211], v2, s[40:43], s48 offen offset:2048 sc1
  v_add_f32 v250, v212, v213
  v_mfma_f32_16x16x32_bf16 v[196:199], a[100:103], v[104:107], v[196:199]
  ds_write_b128 v254, a[52:55] offset:13312
  v_mfma_f32_16x16x32_bf16 v[200:203], a[104:107], v[104:107], v[200:203]
  ds_write_b128 v254, a[56:59] offset:14336
  v_mfma_f32_16x16x32_bf16 v[204:207], a[108:111], v[104:107], v[204:207]
  buffer_load_dwordx4 a[212:215], v3, s[40:43], s48 offen offset:2048 sc1
  v_add_f32 v251, v214, v215
  v_mfma_f32_16x16x32_bf16 v[208:211], a[112:115], v[104:107], v[208:211]
  ds_write_b128 v254, a[60:63] offset:15360
  v_accvgpr_read_b32 v216, a96
  s_mov_b32 s35, 0x53800000
  s_mov_b32 s36, 0x2b800000
  v_max3_f32 v248, v248, v215, v216
  v_min3_f32 v249, v249, v215, v216
  v_add_f32 v250, v250, v216
  ds_write_b32 v7, v216 offset:1024
  v_add_f32 v250, v250, v251
  v_cmp_nge_f32 vcc, s35, v248
  v_cmp_nle_f32 s[62:63], s36, v249
  v_cmp_u_f32 s[10:11], v250, v250
  ds_write_b128 v254, a[64:67] offset:16384
  ds_write_b128 v254, a[68:71] offset:17408
  ds_write_b128 v254, a[72:75] offset:18432
  ds_write_b128 v254, a[76:79] offset:19456
  s_or_b64 vcc, vcc, s[62:63]
  s_or_b64 vcc, vcc, s[10:11]
  s_cmp_lg_u64 vcc, 0
  s_cselect_b32 s35, 1, 0
  v_mov_b32 v251, s35
  ds_write_b32 v252, v251
  s_waitcnt lgkmcnt(0)
  s_barrier
  ds_read_b128 v[220:223], v253
  ds_read_b32 v228, v8 offset:0
  ds_read_b32 v230, v8 offset:256
  ds_read_b32 v232, v8 offset:512
  ds_read_b32 v234, v8 offset:768
  ds_read_b32 v236, v8 offset:1024
  ds_read_b128 v[32:35], v255 offset:0
  ds_read_b128 v[36:39], v255 offset:1024
  ds_read_b128 v[40:43], v255 offset:2048
  ds_read_b128 v[44:47], v255 offset:3072
  ds_read_b128 v[48:51], v255 offset:4096
  ds_read_b128 v[52:55], v255 offset:5120
  ds_read_b128 v[56:59], v255 offset:6144
  ds_read_b128 v[60:63], v255 offset:7168
  ds_read_b128 v[64:67], v255 offset:8192
  ds_read_b128 v[68:71], v255 offset:9216
  ds_read_b128 v[72:75], v255 offset:10240
  ds_read_b128 v[76:79], v255 offset:11264
  ds_read_b128 v[80:83], v255 offset:12288
  ds_read_b128 v[84:87], v255 offset:13312
  ds_read_b128 v[88:91], v255 offset:14336
  ds_read_b128 v[92:95], v255 offset:15360
  ds_read_b128 v[96:99], v255 offset:16384
  ds_read_b128 v[100:103], v255 offset:17408
  ds_read_b128 v[104:107], v255 offset:18432
  ds_read_b128 v[108:111], v255 offset:19456
  buffer_load_dwordx4 a[96:99], v1, s[40:43], s51 offen offset:2048 sc1
  buffer_load_dwordx4 a[100:103], v2, s[40:43], s51 offen offset:2048 sc1
  buffer_load_dwordx4 a[104:107], v3, s[40:43], s51 offen offset:2048 sc1
  buffer_load_dwordx4 a[108:111], v1, s[40:43], s51 offen offset:3072 sc1
  buffer_load_dwordx4 a[112:115], v2, s[40:43], s51 offen offset:3072 sc1
  buffer_load_dwordx4 a[116:119], v3, s[40:43], s51 offen offset:3072 sc1
  buffer_load_dwordx4 a[120:123], v1, s[40:43], s52 offen sc1
  buffer_load_dwordx4 a[124:127], v2, s[40:43], s52 offen sc1
  buffer_load_dwordx4 a[128:131], v3, s[40:43], s52 offen sc1
  s_waitcnt lgkmcnt(14)
  v_or3_b32 v248, v220, v221, v222
  v_or_b32 v248, v248, v223
  s_nop 0
  v_readfirstlane_b32 s36, v248
  s_nop 0
  s_andn2_b32 s36, s36, s58
  s_cmp_lg_u32 s36, 0
  s_cbranch_scc1 L_fallback
  v_add_f32 v228, v228, v212
  v_add_f32 v230, v230, v213
  v_add_f32 v232, v232, v214
  v_add_f32 v234, v234, v215
  v_add_f32 v236, v236, v216
  v_rcp_f32 v228, v228
  v_rcp_f32 v230, v230
  v_rcp_f32 v232, v232
  v_rcp_f32 v234, v234
  v_rcp_f32 v236, v236
  s_waitcnt lgkmcnt(14)
  v_pk_add_f32 v[132:133], v[132:133], v[32:33]
  v_pk_add_f32 v[134:135], v[134:135], v[34:35]
  v_pk_mul_f32 v[132:133], v[132:133], v[228:229] op_sel_hi:[1,0]
  v_pk_mul_f32 v[134:135], v[134:135], v[228:229] op_sel_hi:[1,0]
  v_pk_add_f32 v[136:137], v[136:137], v[36:37]
  v_pk_add_f32 v[138:139], v[138:139], v[38:39]
  v_pk_mul_f32 v[136:137], v[136:137], v[228:229] op_sel_hi:[1,0]
  v_pk_mul_f32 v[138:139], v[138:139], v[228:229] op_sel_hi:[1,0]
  v_cvt_pk_bf16_f32 v132, v132, v133
  v_cvt_pk_bf16_f32 v133, v134, v135
  v_cvt_pk_bf16_f32 v134, v136, v137
  v_cvt_pk_bf16_f32 v135, v138, v139
  s_add_u32 s36, s59, 0
  buffer_store_dwordx4 v[132:135], v30, s[20:23], s36 offen sc1
  v_pk_add_f32 v[140:141], v[140:141], v[40:41]
  v_pk_add_f32 v[142:143], v[142:143], v[42:43]
  v_pk_mul_f32 v[140:141], v[140:141], v[228:229] op_sel_hi:[1,0]
  v_pk_mul_f32 v[142:143], v[142:143], v[228:229] op_sel_hi:[1,0]
  v_pk_add_f32 v[144:145], v[144:145], v[44:45]
  v_pk_add_f32 v[146:147], v[146:147], v[46:47]
  v_pk_mul_f32 v[144:145], v[144:145], v[228:229] op_sel_hi:[1,0]
  v_pk_mul_f32 v[146:147], v[146:147], v[228:229] op_sel_hi:[1,0]
  v_cvt_pk_bf16_f32 v140, v140, v141
  v_cvt_pk_bf16_f32 v141, v142, v143
  v_cvt_pk_bf16_f32 v142, v144, v145
  v_cvt_pk_bf16_f32 v143, v146, v147
  s_add_u32 s36, s59, 1024
  buffer_store_dwordx4 v[140:143], v30, s[20:23], s36 offen sc1
  s_waitcnt lgkmcnt(12)
  v_pk_add_f32 v[148:149], v[148:149], v[48:49]
  v_pk_add_f32 v[150:151], v[150:151], v[50:51]
  v_pk_mul_f32 v[148:149], v[148:149], v[230:231] op_sel_hi:[1,0]
  v_pk_mul_f32 v[150:151], v[150:151], v[230:231] op_sel_hi:[1,0]
  v_pk_add_f32 v[152:153], v[152:153], v[52:53]
  v_pk_add_f32 v[154:155], v[154:155], v[54:55]
  v_pk_mul_f32 v[152:153], v[152:153], v[230:231] op_sel_hi:[1,0]
  v_pk_mul_f32 v[154:155], v[154:155], v[230:231] op_sel_hi:[1,0]
  v_cvt_pk_bf16_f32 v148, v148, v149
  v_cvt_pk_bf16_f32 v149, v150, v151
  v_cvt_pk_bf16_f32 v150, v152, v153
  v_cvt_pk_bf16_f32 v151, v154, v155
  s_add_u32 s36, s59, 131072
  buffer_store_dwordx4 v[148:151], v30, s[20:23], s36 offen sc1
  v_pk_add_f32 v[156:157], v[156:157], v[56:57]
  v_pk_add_f32 v[158:159], v[158:159], v[58:59]
  v_pk_mul_f32 v[156:157], v[156:157], v[230:231] op_sel_hi:[1,0]
  v_pk_mul_f32 v[158:159], v[158:159], v[230:231] op_sel_hi:[1,0]
  v_pk_add_f32 v[160:161], v[160:161], v[60:61]
  v_pk_add_f32 v[162:163], v[162:163], v[62:63]
  v_pk_mul_f32 v[160:161], v[160:161], v[230:231] op_sel_hi:[1,0]
  v_pk_mul_f32 v[162:163], v[162:163], v[230:231] op_sel_hi:[1,0]
  v_cvt_pk_bf16_f32 v156, v156, v157
  v_cvt_pk_bf16_f32 v157, v158, v159
  v_cvt_pk_bf16_f32 v158, v160, v161
  v_cvt_pk_bf16_f32 v159, v162, v163
  s_add_u32 s36, s59, 132096
  buffer_store_dwordx4 v[156:159], v30, s[20:23], s36 offen sc1
  s_waitcnt lgkmcnt(8)
  v_pk_add_f32 v[164:165], v[164:165], v[64:65]
  v_pk_add_f32 v[166:167], v[166:167], v[66:67]
  v_pk_mul_f32 v[164:165], v[164:165], v[232:233] op_sel_hi:[1,0]
  v_pk_mul_f32 v[166:167], v[166:167], v[232:233] op_sel_hi:[1,0]
  v_pk_add_f32 v[168:169], v[168:169], v[68:69]
  v_pk_add_f32 v[170:171], v[170:171], v[70:71]
  v_pk_mul_f32 v[168:169], v[168:169], v[232:233] op_sel_hi:[1,0]
  v_pk_mul_f32 v[170:171], v[170:171], v[232:233] op_sel_hi:[1,0]
  v_cvt_pk_bf16_f32 v164, v164, v165
  v_cvt_pk_bf16_f32 v165, v166, v167
  v_cvt_pk_bf16_f32 v166, v168, v169
  v_cvt_pk_bf16_f32 v167, v170, v171
  s_add_u32 s36, s59, 262144
  buffer_store_dwordx4 v[164:167], v30, s[20:23], s36 offen sc1
  v_pk_add_f32 v[172:173], v[172:173], v[72:73]
  v_pk_add_f32 v[174:175], v[174:175], v[74:75]
  v_pk_mul_f32 v[172:173], v[172:173], v[232:233] op_sel_hi:[1,0]
  v_pk_mul_f32 v[174:175], v[174:175], v[232:233] op_sel_hi:[1,0]
  v_pk_add_f32 v[176:177], v[176:177], v[76:77]
  v_pk_add_f32 v[178:179], v[178:179], v[78:79]
  v_pk_mul_f32 v[176:177], v[176:177], v[232:233] op_sel_hi:[1,0]
  v_pk_mul_f32 v[178:179], v[178:179], v[232:233] op_sel_hi:[1,0]
  v_cvt_pk_bf16_f32 v172, v172, v173
  v_cvt_pk_bf16_f32 v173, v174, v175
  v_cvt_pk_bf16_f32 v174, v176, v177
  v_cvt_pk_bf16_f32 v175, v178, v179
  s_add_u32 s36, s59, 263168
  buffer_store_dwordx4 v[172:175], v30, s[20:23], s36 offen sc1
  s_waitcnt lgkmcnt(4)
  v_pk_add_f32 v[180:181], v[180:181], v[80:81]
  v_pk_add_f32 v[182:183], v[182:183], v[82:83]
  v_pk_mul_f32 v[180:181], v[180:181], v[234:235] op_sel_hi:[1,0]
  v_pk_mul_f32 v[182:183], v[182:183], v[234:235] op_sel_hi:[1,0]
  v_pk_add_f32 v[184:185], v[184:185], v[84:85]
  v_pk_add_f32 v[186:187], v[186:187], v[86:87]
  v_pk_mul_f32 v[184:185], v[184:185], v[234:235] op_sel_hi:[1,0]
  v_pk_mul_f32 v[186:187], v[186:187], v[234:235] op_sel_hi:[1,0]
  v_cvt_pk_bf16_f32 v180, v180, v181
  v_cvt_pk_bf16_f32 v181, v182, v183
  v_cvt_pk_bf16_f32 v182, v184, v185
  v_cvt_pk_bf16_f32 v183, v186, v187
  s_add_u32 s36, s59, 393216
  buffer_store_dwordx4 v[180:183], v30, s[20:23], s36 offen sc1
  v_pk_add_f32 v[188:189], v[188:189], v[88:89]
  v_pk_add_f32 v[190:191], v[190:191], v[90:91]
  v_pk_mul_f32 v[188:189], v[188:189], v[234:235] op_sel_hi:[1,0]
  v_pk_mul_f32 v[190:191], v[190:191], v[234:235] op_sel_hi:[1,0]
  v_pk_add_f32 v[192:193], v[192:193], v[92:93]
  v_pk_add_f32 v[194:195], v[194:195], v[94:95]
  v_pk_mul_f32 v[192:193], v[192:193], v[234:235] op_sel_hi:[1,0]
  v_pk_mul_f32 v[194:195], v[194:195], v[234:235] op_sel_hi:[1,0]
  v_cvt_pk_bf16_f32 v188, v188, v189
  v_cvt_pk_bf16_f32 v189, v190, v191
  v_cvt_pk_bf16_f32 v190, v192, v193
  v_cvt_pk_bf16_f32 v191, v194, v195
  s_add_u32 s36, s59, 394240
  buffer_store_dwordx4 v[188:191], v30, s[20:23], s36 offen sc1
  s_waitcnt lgkmcnt(0)
  v_pk_add_f32 v[196:197], v[196:197], v[96:97]
  v_pk_add_f32 v[198:199], v[198:199], v[98:99]
  v_pk_mul_f32 v[196:197], v[196:197], v[236:237] op_sel_hi:[1,0]
  v_pk_mul_f32 v[198:199], v[198:199], v[236:237] op_sel_hi:[1,0]
  v_pk_add_f32 v[200:201], v[200:201], v[100:101]
  v_pk_add_f32 v[202:203], v[202:203], v[102:103]
  v_pk_mul_f32 v[200:201], v[200:201], v[236:237] op_sel_hi:[1,0]
  v_pk_mul_f32 v[202:203], v[202:203], v[236:237] op_sel_hi:[1,0]
  v_cvt_pk_bf16_f32 v196, v196, v197
  v_cvt_pk_bf16_f32 v197, v198, v199
  v_cvt_pk_bf16_f32 v198, v200, v201
  v_cvt_pk_bf16_f32 v199, v202, v203
  s_add_u32 s36, s59, 524288
  buffer_store_dwordx4 v[196:199], v30, s[20:23], s36 offen sc1
  v_pk_add_f32 v[204:205], v[204:205], v[104:105]
  v_pk_add_f32 v[206:207], v[206:207], v[106:107]
  v_pk_mul_f32 v[204:205], v[204:205], v[236:237] op_sel_hi:[1,0]
  v_pk_mul_f32 v[206:207], v[206:207], v[236:237] op_sel_hi:[1,0]
  v_pk_add_f32 v[208:209], v[208:209], v[108:109]
  v_pk_add_f32 v[210:211], v[210:211], v[110:111]
  v_pk_mul_f32 v[208:209], v[208:209], v[236:237] op_sel_hi:[1,0]
  v_pk_mul_f32 v[210:211], v[210:211], v[236:237] op_sel_hi:[1,0]
  v_cvt_pk_bf16_f32 v204, v204, v205
  v_cvt_pk_bf16_f32 v205, v206, v207
  v_cvt_pk_bf16_f32 v206, v208, v209
  v_cvt_pk_bf16_f32 v207, v210, v211
  s_add_u32 s36, s59, 525312
  buffer_store_dwordx4 v[204:207], v30, s[20:23], s36 offen sc1
  s_cmp_eq_u32 s9, 0
  s_cbranch_scc1 L_nocons
  buffer_load_dwordx4 a[0:3], v1, s[40:43], s49 offen offset:2048 sc1
  buffer_load_dwordx4 a[4:7], v2, s[40:43], s49 offen offset:2048 sc1
  s_waitcnt vmcnt(56)
  buffer_load_dwordx4 a[8:11], v3, s[40:43], s49 offen offset:2048 sc1
  buffer_load_dwordx4 a[12:15], v1, s[40:43], s49 offen offset:3072 sc1
  buffer_load_dwordx4 a[16:19], v2, s[40:43], s49 offen offset:3072 sc1
  buffer_load_dwordx4 a[20:23], v3, s[40:43], s49 offen offset:3072 sc1
  s_waitcnt vmcnt(56)
  buffer_load_dwordx4 a[24:27], v1, s[40:43], s50 offen sc1
  buffer_load_dwordx4 a[28:31], v2, s[40:43], s50 offen sc1
  buffer_load_dwordx4 a[32:35], v3, s[40:43], s50 offen sc1
  buffer_load_dwordx4 a[36:39], v1, s[40:43], s50 offen offset:1024 sc1
  s_waitcnt vmcnt(56)
  buffer_load_dwordx4 a[40:43], v2, s[40:43], s50 offen offset:1024 sc1
  buffer_load_dwordx4 a[44:47], v3, s[40:43], s50 offen offset:1024 sc1
  buffer_load_dwordx4 a[48:51], v1, s[40:43], s50 offen offset:2048 sc1
  buffer_load_dwordx4 a[52:55], v2, s[40:43], s50 offen offset:2048 sc1
  s_waitcnt vmcnt(56)
  buffer_load_dwordx4 a[56:59], v3, s[40:43], s50 offen offset:2048 sc1
  buffer_load_dwordx4 a[60:63], v1, s[40:43], s50 offen offset:3072 sc1
  buffer_load_dwordx4 a[64:67], v2, s[40:43], s50 offen offset:3072 sc1
  buffer_load_dwordx4 a[68:71], v3, s[40:43], s50 offen offset:3072 sc1
  s_waitcnt vmcnt(18)
  s_barrier
  s_cmp_lg_u32 s24, 0
  s_cbranch_scc1 L_no_arr_o
  s_mov_b32 exec_hi, 0
  v_mov_b32 v7, 1
  v_lshlrev_b32 v8, 7, v17
  buffer_atomic_add v7, v8, s[20:23], s39 offen
  s_mov_b64 exec, -1
L_no_arr_o:
  v_mov_b32 v6, s7
  v_and_b32 v5, 15, v17
  v_lshrrev_b32 v11, 2, v17
  v_writelane_b32 v6, s8, 1
  v_mul_u32_u24 v11, 96, v11
  v_and_b32 v10, 3, v17
  v_lshlrev_b32 v10, 3, v10
  v_add3_u32 v11, v11, v10, s55
  s_lshl_b32 s35, s24, 4
  v_add_u32 v5, s35, v5
  v_mul_u32_u24 v5, 1152, v5
  v_lshrrev_b32 v8, 4, v17
  v_lshlrev_b32 v8, 3, v8
  v_add_u32 v5, v5, v8
  v_add_u32 v10, 0x22000, v11
  v_add_u32 v11, 0x14000, v11
  v_mov_b32 v9, v30
  buffer_load_dwordx4 a[72:75], v1, s[40:43], s51 offen sc1
  buffer_load_dwordx4 a[76:79], v2, s[40:43], s51 offen sc1
  buffer_load_dwordx4 a[80:83], v3, s[40:43], s51 offen sc1
  buffer_load_dwordx4 a[84:87], v1, s[40:43], s51 offen offset:1024 sc1
  buffer_load_dwordx4 a[88:91], v2, s[40:43], s51 offen offset:1024 sc1
  buffer_load_dwordx4 a[92:95], v3, s[40:43], s51 offen offset:1024 sc1
  buffer_load_dwordx4 v[160:163], v1, s[40:43], s53 offen sc1
  buffer_load_dwordx4 v[164:167], v2, s[40:43], s53 offen sc1
  buffer_load_dwordx4 v[168:171], v3, s[40:43], s53 offen sc1
  buffer_load_dwordx4 v[172:175], v1, s[40:43], s53 offen offset:1024 sc1
  buffer_load_dwordx4 v[176:179], v2, s[40:43], s53 offen offset:1024 sc1
  buffer_load_dwordx4 v[180:183], v3, s[40:43], s53 offen offset:1024 sc1
  buffer_load_dwordx4 v[184:187], v1, s[40:43], s53 offen offset:2048 sc1
  buffer_load_dwordx4 v[188:191], v2, s[40:43], s53 offen offset:2048 sc1
  buffer_load_dwordx4 v[192:195], v3, s[40:43], s53 offen offset:2048 sc1
  s_cmp_lg_u32 s24, 0
  s_cbranch_scc1 L_poll_skip1
  buffer_load_dword v7, v6, s[20:23], 0 offen sc1
L_poll_skip1:
  buffer_load_dwordx4 v[196:199], v1, s[40:43], s53 offen offset:3072 sc1
  buffer_load_dwordx4 v[200:203], v2, s[40:43], s53 offen offset:3072 sc1
  buffer_load_dwordx4 v[204:207], v3, s[40:43], s53 offen offset:3072 sc1
  buffer_load_dwordx4 v[208:211], v1, s[40:43], s54 offen sc1
  buffer_load_dwordx4 v[212:215], v2, s[40:43], s54 offen sc1
  buffer_load_dwordx4 v[216:219], v3, s[40:43], s54 offen sc1
  buffer_load_dwordx4 v[220:223], v1, s[40:43], s54 offen offset:1024 sc1
  buffer_load_dwordx4 v[224:227], v2, s[40:43], s54 offen offset:1024 sc1
  buffer_load_dwordx4 v[228:231], v3, s[40:43], s54 offen offset:1024 sc1
  buffer_load_dwordx4 v[232:235], v1, s[40:43], s54 offen offset:2048 sc1
  buffer_load_dwordx4 v[236:239], v2, s[40:43], s54 offen offset:2048 sc1
  buffer_load_dwordx4 v[240:243], v3, s[40:43], s54 offen offset:2048 sc1
  buffer_load_dwordx4 v[244:247], v1, s[40:43], s54 offen offset:3072 sc1
  buffer_load_dwordx4 v[248:251], v2, s[40:43], s54 offen offset:3072 sc1
  buffer_load_dwordx4 v[252:255], v3, s[40:43], s54 offen offset:3072 sc1
  s_cmp_lg_u32 s24, 0
  s_cbranch_scc1 L_poll_done
  s_mov_b32 s36, 131072
  s_waitcnt vmcnt(15)
L_poll_chk:
  v_cmp_eq_u32 vcc, 32, v7
  s_nop 1
  s_cmp_eq_u64 vcc, -1
  s_cbranch_scc1 L_poll_done
  s_sub_u32 s36, s36, 1
  s_cmp_eq_u32 s36, 0
  s_cbranch_scc1 L_poll_done
  s_sleep 2
  buffer_load_dword v7, v6, s[20:23], 0 offen sc1
  s_waitcnt vmcnt(0)
  s_branch L_poll_chk
L_poll_done:
  s_barrier
  buffer_load_dwordx4 v[60:63], v1, s[20:23], s4 offen sc1
  buffer_load_dwordx4 v[64:67], v2, s[20:23], s4 offen sc1
  buffer_load_dwordx4 v[68:71], v3, s[20:23], s4 offen sc1
  buffer_load_dwordx4 v[72:75], v4, s[20:23], s4 offen sc1
  buffer_load_dwordx4 v[76:79], v1, s[20:23], s4 offen offset:1024 sc1
  buffer_load_dwordx4 v[80:83], v2, s[20:23], s4 offen offset:1024 sc1
  buffer_load_dwordx4 v[84:87], v3, s[20:23], s4 offen offset:1024 sc1
  buffer_load_dwordx4 v[88:91], v4, s[20:23], s4 offen offset:1024 sc1
  buffer_load_dwordx4 v[92:95], v1, s[20:23], s4 offen offset:2048 sc1
  buffer_load_dwordx4 v[96:99], v2, s[20:23], s4 offen offset:2048 sc1
  buffer_load_dwordx4 v[100:103], v3, s[20:23], s4 offen offset:2048 sc1
  buffer_load_dwordx4 v[104:107], v4, s[20:23], s4 offen offset:2048 sc1
  s_waitcnt vmcnt(56)
  buffer_load_dwordx4 v[108:111], v1, s[20:23], s4 offen offset:3072 sc1
  buffer_load_dwordx4 v[112:115], v2, s[20:23], s4 offen offset:3072 sc1
  buffer_load_dwordx4 v[116:119], v3, s[20:23], s4 offen offset:3072 sc1
  buffer_load_dwordx4 v[120:123], v4, s[20:23], s4 offen offset:3072 sc1
  s_add_u32 s4, s4, 4096
  s_waitcnt vmcnt(56)
  buffer_load_dwordx4 v[124:127], v1, s[20:23], s4 offen sc1
  buffer_load_dwordx4 v[128:131], v2, s[20:23], s4 offen sc1
  buffer_load_dwordx4 v[132:135], v3, s[20:23], s4 offen sc1
  buffer_load_dwordx4 v[136:139], v4, s[20:23], s4 offen sc1
  s_waitcnt vmcnt(56)
  buffer_load_dwordx4 v[140:143], v1, s[20:23], s4 offen offset:1024 sc1
  buffer_load_dwordx4 v[144:147], v2, s[20:23], s4 offen offset:1024 sc1
  buffer_load_dwordx4 v[148:151], v3, s[20:23], s4 offen offset:1024 sc1
  buffer_load_dwordx4 v[152:155], v4, s[20:23], s4 offen offset:1024 sc1
  s_waitcnt vmcnt(20)
  v_mfma_f32_16x16x32_bf16 v[12:15], a[132:135], v[60:63], 0
  v_mfma_f32_16x16x32_bf16 v[24:27], a[132:135], v[64:67], 0
  v_mfma_f32_16x16x32_bf16 v[36:39], a[132:135], v[68:71], 0
  v_mfma_f32_16x16x32_bf16 v[48:51], a[132:135], v[72:75], 0
  v_mfma_f32_16x16x32_bf16 v[16:19], a[136:139], v[60:63], 0
  v_mfma_f32_16x16x32_bf16 v[28:31], a[136:139], v[64:67], 0
  v_mfma_f32_16x16x32_bf16 v[40:43], a[136:139], v[68:71], 0
  v_mfma_f32_16x16x32_bf16 v[52:55], a[136:139], v[72:75], 0
  v_mfma_f32_16x16x32_bf16 v[20:23], a[140:143], v[60:63], 0
  v_mfma_f32_16x16x32_bf16 v[32:35], a[140:143], v[64:67], 0
  v_mfma_f32_16x16x32_bf16 v[44:47], a[140:143], v[68:71], 0
  v_mfma_f32_16x16x32_bf16 v[56:59], a[140:143], v[72:75], 0
  buffer_load_dwordx4 v[60:63], v1, s[20:23], s4 offen offset:2048 sc1
  buffer_load_dwordx4 v[64:67], v2, s[20:23], s4 offen offset:2048 sc1
  buffer_load_dwordx4 v[68:71], v3, s[20:23], s4 offen offset:2048 sc1
  buffer_load_dwordx4 v[72:75], v4, s[20:23], s4 offen offset:2048 sc1
  s_waitcnt vmcnt(20)
  v_mfma_f32_16x16x32_bf16 v[12:15], a[144:147], v[76:79], v[12:15]
  v_mfma_f32_16x16x32_bf16 v[24:27], a[144:147], v[80:83], v[24:27]
  v_mfma_f32_16x16x32_bf16 v[36:39], a[144:147], v[84:87], v[36:39]
  v_mfma_f32_16x16x32_bf16 v[48:51], a[144:147], v[88:91], v[48:51]
  v_mfma_f32_16x16x32_bf16 v[16:19], a[148:151], v[76:79], v[16:19]
  v_mfma_f32_16x16x32_bf16 v[28:31], a[148:151], v[80:83], v[28:31]
  v_mfma_f32_16x16x32_bf16 v[40:43], a[148:151], v[84:87], v[40:43]
  v_mfma_f32_16x16x32_bf16 v[52:55], a[148:151], v[88:91], v[52:55]
  v_mfma_f32_16x16x32_bf16 v[20:23], a[152:155], v[76:79], v[20:23]
  v_mfma_f32_16x16x32_bf16 v[32:35], a[152:155], v[80:83], v[32:35]
  v_mfma_f32_16x16x32_bf16 v[44:47], a[152:155], v[84:87], v[44:47]
  v_mfma_f32_16x16x32_bf16 v[56:59], a[152:155], v[88:91], v[56:59]
  buffer_load_dwordx4 v[76:79], v1, s[20:23], s4 offen offset:3072 sc1
  buffer_load_dwordx4 v[80:83], v2, s[20:23], s4 offen offset:3072 sc1
  buffer_load_dwordx4 v[84:87], v3, s[20:23], s4 offen offset:3072 sc1
  buffer_load_dwordx4 v[88:91], v4, s[20:23], s4 offen offset:3072 sc1
  s_waitcnt vmcnt(20)
  v_mfma_f32_16x16x32_bf16 v[12:15], a[156:159], v[92:95], v[12:15]
  v_mfma_f32_16x16x32_bf16 v[24:27], a[156:159], v[96:99], v[24:27]
  v_mfma_f32_16x16x32_bf16 v[36:39], a[156:159], v[100:103], v[36:39]
  v_mfma_f32_16x16x32_bf16 v[48:51], a[156:159], v[104:107], v[48:51]
  v_mfma_f32_16x16x32_bf16 v[16:19], a[160:163], v[92:95], v[16:19]
  v_mfma_f32_16x16x32_bf16 v[28:31], a[160:163], v[96:99], v[28:31]
  v_mfma_f32_16x16x32_bf16 v[40:43], a[160:163], v[100:103], v[40:43]
  v_mfma_f32_16x16x32_bf16 v[52:55], a[160:163], v[104:107], v[52:55]
  v_mfma_f32_16x16x32_bf16 v[20:23], a[164:167], v[92:95], v[20:23]
  v_mfma_f32_16x16x32_bf16 v[32:35], a[164:167], v[96:99], v[32:35]
  v_mfma_f32_16x16x32_bf16 v[44:47], a[164:167], v[100:103], v[44:47]
  v_mfma_f32_16x16x32_bf16 v[56:59], a[164:167], v[104:107], v[56:59]
  s_add_u32 s4, s4, 4096
  buffer_load_dwordx4 v[92:95], v1, s[20:23], s4 offen sc1
  buffer_load_dwordx4 v[96:99], v2, s[20:23], s4 offen sc1
  buffer_load_dwordx4 v[100:103], v3, s[20:23], s4 offen sc1
  buffer_load_dwordx4 v[104:107], v4, s[20:23], s4 offen sc1
  s_waitcnt vmcnt(20)
  v_mfma_f32_16x16x32_bf16 v[12:15], a[168:171], v[108:111], v[12:15]
  v_mfma_f32_16x16x32_bf16 v[24:27], a[168:171], v[112:115], v[24:27]
  v_mfma_f32_16x16x32_bf16 v[36:39], a[168:171], v[116:119], v[36:39]
  v_mfma_f32_16x16x32_bf16 v[48:51], a[168:171], v[120:123], v[48:51]
  v_mfma_f32_16x16x32_bf16 v[16:19], a[172:175], v[108:111], v[16:19]
  v_mfma_f32_16x16x32_bf16 v[28:31], a[172:175], v[112:115], v[28:31]
  v_mfma_f32_16x16x32_bf16 v[40:43], a[172:175], v[116:119], v[40:43]
  v_mfma_f32_16x16x32_bf16 v[52:55], a[172:175], v[120:123], v[52:55]
  v_mfma_f32_16x16x32_bf16 v[20:23], a[176:179], v[108:111], v[20:23]
  v_mfma_f32_16x16x32_bf16 v[32:35], a[176:179], v[112:115], v[32:35]
  v_mfma_f32_16x16x32_bf16 v[44:47], a[176:179], v[116:119], v[44:47]
  v_mfma_f32_16x16x32_bf16 v[56:59], a[176:179], v[120:123], v[56:59]
  buffer_load_dwordx4 v[108:111], v1, s[20:23], s4 offen offset:1024 sc1
  buffer_load_dwordx4 v[112:115], v2, s[20:23], s4 offen offset:1024 sc1
  buffer_load_dwordx4 v[116:119], v3, s[20:23], s4 offen offset:1024 sc1
  buffer_load_dwordx4 v[120:123], v4, s[20:23], s4 offen offset:1024 sc1
  s_waitcnt vmcnt(20)
  v_mfma_f32_16x16x32_bf16 v[12:15], a[180:183], v[124:127], v[12:15]
  v_mfma_f32_16x16x32_bf16 v[24:27], a[180:183], v[128:131], v[24:27]
  v_mfma_f32_16x16x32_bf16 v[36:39], a[180:183], v[132:135], v[36:39]
  v_mfma_f32_16x16x32_bf16 v[48:51], a[180:183], v[136:139], v[48:51]
  v_mfma_f32_16x16x32_bf16 v[16:19], a[184:187], v[124:127], v[16:19]
  v_mfma_f32_16x16x32_bf16 v[28:31], a[184:187], v[128:131], v[28:31]
  v_mfma_f32_16x16x32_bf16 v[40:43], a[184:187], v[132:135], v[40:43]
  v_mfma_f32_16x16x32_bf16 v[52:55], a[184:187], v[136:139], v[52:55]
  v_mfma_f32_16x16x32_bf16 v[20:23], a[188:191], v[124:127], v[20:23]
  v_mfma_f32_16x16x32_bf16 v[32:35], a[188:191], v[128:131], v[32:35]
  v_mfma_f32_16x16x32_bf16 v[44:47], a[188:191], v[132:135], v[44:47]
  v_mfma_f32_16x16x32_bf16 v[56:59], a[188:191], v[136:139], v[56:59]
  buffer_load_dwordx4 v[124:127], v1, s[20:23], s4 offen offset:2048 sc1
  buffer_load_dwordx4 v[128:131], v2, s[20:23], s4 offen offset:2048 sc1
  buffer_load_dwordx4 v[132:135], v3, s[20:23], s4 offen offset:2048 sc1
  buffer_load_dwordx4 v[136:139], v4, s[20:23], s4 offen offset:2048 sc1
  ds_read_b64_tr_b16 a[132:133], v10 offset:0
  ds_read_b64_tr_b16 a[134:135], v10 offset:1536
  ds_read_b64_tr_b16 a[136:137], v10 offset:32
  ds_read_b64_tr_b16 a[138:139], v10 offset:1568
  ds_read_b64_tr_b16 a[140:141], v10 offset:64
  ds_read_b64_tr_b16 a[142:143], v10 offset:1600
  s_waitcnt vmcnt(20)
  v_mfma_f32_16x16x32_bf16 v[12:15], a[192:195], v[140:143], v[12:15]
  v_mfma_f32_16x16x32_bf16 v[24:27], a[192:195], v[144:147], v[24:27]
  v_mfma_f32_16x16x32_bf16 v[36:39], a[192:195], v[148:151], v[36:39]
  v_mfma_f32_16x16x32_bf16 v[48:51], a[192:195], v[152:155], v[48:51]
  v_mfma_f32_16x16x32_bf16 v[16:19], a[196:199], v[140:143], v[16:19]
  v_mfma_f32_16x16x32_bf16 v[28:31], a[196:199], v[144:147], v[28:31]
  v_mfma_f32_16x16x32_bf16 v[40:43], a[196:199], v[148:151], v[40:43]
  v_mfma_f32_16x16x32_bf16 v[52:55], a[196:199], v[152:155], v[52:55]
  v_mfma_f32_16x16x32_bf16 v[20:23], a[200:203], v[140:143], v[20:23]
  v_mfma_f32_16x16x32_bf16 v[32:35], a[200:203], v[144:147], v[32:35]
  v_mfma_f32_16x16x32_bf16 v[44:47], a[200:203], v[148:151], v[44:47]
  v_mfma_f32_16x16x32_bf16 v[56:59], a[200:203], v[152:155], v[56:59]
  buffer_load_dwordx4 v[140:143], v1, s[20:23], s4 offen offset:3072 sc1
  buffer_load_dwordx4 v[144:147], v2, s[20:23], s4 offen offset:3072 sc1
  buffer_load_dwordx4 v[148:151], v3, s[20:23], s4 offen offset:3072 sc1
  buffer_load_dwordx4 v[152:155], v4, s[20:23], s4 offen offset:3072 sc1
  ds_read_b64_tr_b16 a[144:145], v10 offset:12288
  ds_read_b64_tr_b16 a[146:147], v10 offset:13824
  ds_read_b64_tr_b16 a[148:149], v10 offset:12320
  ds_read_b64_tr_b16 a[150:151], v10 offset:13856
  ds_read_b64_tr_b16 a[152:153], v10 offset:12352
  ds_read_b64_tr_b16 a[154:155], v10 offset:13888
  s_waitcnt vmcnt(20)
  v_mfma_f32_16x16x32_bf16 v[12:15], a[204:207], v[60:63], v[12:15]
  v_mfma_f32_16x16x32_bf16 v[24:27], a[204:207], v[64:67], v[24:27]
  v_mfma_f32_16x16x32_bf16 v[36:39], a[204:207], v[68:71], v[36:39]
  v_mfma_f32_16x16x32_bf16 v[48:51], a[204:207], v[72:75], v[48:51]
  v_mfma_f32_16x16x32_bf16 v[16:19], a[208:211], v[60:63], v[16:19]
  v_mfma_f32_16x16x32_bf16 v[28:31], a[208:211], v[64:67], v[28:31]
  v_mfma_f32_16x16x32_bf16 v[40:43], a[208:211], v[68:71], v[40:43]
  v_mfma_f32_16x16x32_bf16 v[52:55], a[208:211], v[72:75], v[52:55]
  v_mfma_f32_16x16x32_bf16 v[20:23], a[212:215], v[60:63], v[20:23]
  v_mfma_f32_16x16x32_bf16 v[32:35], a[212:215], v[64:67], v[32:35]
  v_mfma_f32_16x16x32_bf16 v[44:47], a[212:215], v[68:71], v[44:47]
  v_mfma_f32_16x16x32_bf16 v[56:59], a[212:215], v[72:75], v[56:59]
  s_add_u32 s4, s4, 4096
  buffer_load_dwordx4 v[60:63], v1, s[20:23], s4 offen sc1
  buffer_load_dwordx4 v[64:67], v2, s[20:23], s4 offen sc1
  buffer_load_dwordx4 v[68:71], v3, s[20:23], s4 offen sc1
  buffer_load_dwordx4 v[72:75], v4, s[20:23], s4 offen sc1
  ds_read_b64_tr_b16 a[156:157], v11 offset:0
  ds_read_b64_tr_b16 a[158:159], v11 offset:1536
  ds_read_b64_tr_b16 a[160:161], v11 offset:32
  ds_read_b64_tr_b16 a[162:163], v11 offset:1568
  ds_read_b64_tr_b16 a[164:165], v11 offset:64
  ds_read_b64_tr_b16 a[166:167], v11 offset:1600
  s_waitcnt vmcnt(20)
  v_mfma_f32_16x16x32_bf16 v[12:15], a[216:219], v[76:79], v[12:15]
  v_mfma_f32_16x16x32_bf16 v[24:27], a[216:219], v[80:83], v[24:27]
  v_mfma_f32_16x16x32_bf16 v[36:39], a[216:219], v[84:87], v[36:39]
  v_mfma_f32_16x16x32_bf16 v[48:51], a[216:219], v[88:91], v[48:51]
  v_mfma_f32_16x16x32_bf16 v[16:19], a[220:223], v[76:79], v[16:19]
  v_mfma_f32_16x16x32_bf16 v[28:31], a[220:223], v[80:83], v[28:31]
  v_mfma_f32_16x16x32_bf16 v[40:43], a[220:223], v[84:87], v[40:43]
  v_mfma_f32_16x16x32_bf16 v[52:55], a[220:223], v[88:91], v[52:55]
  v_mfma_f32_16x16x32_bf16 v[20:23], a[224:227], v[76:79], v[20:23]
  v_mfma_f32_16x16x32_bf16 v[32:35], a[224:227], v[80:83], v[32:35]
  v_mfma_f32_16x16x32_bf16 v[44:47], a[224:227], v[84:87], v[44:47]
  v_mfma_f32_16x16x32_bf16 v[56:59], a[224:227], v[88:91], v[56:59]
  buffer_load_dwordx4 v[76:79], v1, s[20:23], s4 offen offset:1024 sc1
  buffer_load_dwordx4 v[80:83], v2, s[20:23], s4 offen offset:1024 sc1
  buffer_load_dwordx4 v[84:87], v3, s[20:23], s4 offen offset:1024 sc1
  buffer_load_dwordx4 v[88:91], v4, s[20:23], s4 offen offset:1024 sc1
  s_waitcnt vmcnt(20)
  v_mfma_f32_16x16x32_bf16 v[12:15], a[228:231], v[92:95], v[12:15]
  v_mfma_f32_16x16x32_bf16 v[24:27], a[228:231], v[96:99], v[24:27]
  v_mfma_f32_16x16x32_bf16 v[36:39], a[228:231], v[100:103], v[36:39]
  v_mfma_f32_16x16x32_bf16 v[48:51], a[228:231], v[104:107], v[48:51]
  v_mfma_f32_16x16x32_bf16 v[16:19], a[232:235], v[92:95], v[16:19]
  v_mfma_f32_16x16x32_bf16 v[28:31], a[232:235], v[96:99], v[28:31]
  v_mfma_f32_16x16x32_bf16 v[40:43], a[232:235], v[100:103], v[40:43]
  v_mfma_f32_16x16x32_bf16 v[52:55], a[232:235], v[104:107], v[52:55]
  v_mfma_f32_16x16x32_bf16 v[20:23], a[236:239], v[92:95], v[20:23]
  v_mfma_f32_16x16x32_bf16 v[32:35], a[236:239], v[96:99], v[32:35]
  v_mfma_f32_16x16x32_bf16 v[44:47], a[236:239], v[100:103], v[44:47]
  v_mfma_f32_16x16x32_bf16 v[56:59], a[236:239], v[104:107], v[56:59]
  buffer_load_dwordx4 v[92:95], v1, s[20:23], s4 offen offset:2048 sc1
  buffer_load_dwordx4 v[96:99], v2, s[20:23], s4 offen offset:2048 sc1
  buffer_load_dwordx4 v[100:103], v3, s[20:23], s4 offen offset:2048 sc1
  buffer_load_dwordx4 v[104:107], v4, s[20:23], s4 offen offset:2048 sc1
  s_waitcnt vmcnt(20)
  v_mfma_f32_16x16x32_bf16 v[12:15], a[240:243], v[108:111], v[12:15]
  v_mfma_f32_16x16x32_bf16 v[24:27], a[240:243], v[112:115], v[24:27]
  v_mfma_f32_16x16x32_bf16 v[36:39], a[240:243], v[116:119], v[36:39]
  v_mfma_f32_16x16x32_bf16 v[48:51], a[240:243], v[120:123], v[48:51]
  v_mfma_f32_16x16x32_bf16 v[16:19], a[244:247], v[108:111], v[16:19]
  v_mfma_f32_16x16x32_bf16 v[28:31], a[244:247], v[112:115], v[28:31]
  v_mfma_f32_16x16x32_bf16 v[40:43], a[244:247], v[116:119], v[40:43]
  v_mfma_f32_16x16x32_bf16 v[52:55], a[244:247], v[120:123], v[52:55]
  v_mfma_f32_16x16x32_bf16 v[20:23], a[248:251], v[108:111], v[20:23]
  v_mfma_f32_16x16x32_bf16 v[32:35], a[248:251], v[112:115], v[32:35]
  v_mfma_f32_16x16x32_bf16 v[44:47], a[248:251], v[116:119], v[44:47]
  v_mfma_f32_16x16x32_bf16 v[56:59], a[248:251], v[120:123], v[56:59]
  buffer_load_dwordx4 v[108:111], v1, s[20:23], s4 offen offset:3072 sc1
  buffer_load_dwordx4 v[112:115], v2, s[20:23], s4 offen offset:3072 sc1
  buffer_load_dwordx4 v[116:119], v3, s[20:23], s4 offen offset:3072 sc1
  buffer_load_dwordx4 v[120:123], v4, s[20:23], s4 offen offset:3072 sc1
  s_waitcnt vmcnt(20)
  v_mfma_f32_16x16x32_bf16 v[12:15], a[0:3], v[124:127], v[12:15]
  v_mfma_f32_16x16x32_bf16 v[24:27], a[0:3], v[128:131], v[24:27]
  v_mfma_f32_16x16x32_bf16 v[36:39], a[0:3], v[132:135], v[36:39]
  v_mfma_f32_16x16x32_bf16 v[48:51], a[0:3], v[136:139], v[48:51]
  v_mfma_f32_16x16x32_bf16 v[16:19], a[4:7], v[124:127], v[16:19]
  v_mfma_f32_16x16x32_bf16 v[28:31], a[4:7], v[128:131], v[28:31]
  v_mfma_f32_16x16x32_bf16 v[40:43], a[4:7], v[132:135], v[40:43]
  v_mfma_f32_16x16x32_bf16 v[52:55], a[4:7], v[136:139], v[52:55]
  v_mfma_f32_16x16x32_bf16 v[20:23], a[8:11], v[124:127], v[20:23]
  v_mfma_f32_16x16x32_bf16 v[32:35], a[8:11], v[128:131], v[32:35]
  v_mfma_f32_16x16x32_bf16 v[44:47], a[8:11], v[132:135], v[44:47]
  v_mfma_f32_16x16x32_bf16 v[56:59], a[8:11], v[136:139], v[56:59]
  s_add_u32 s4, s4, 4096
  buffer_load_dwordx4 v[124:127], v1, s[20:23], s4 offen sc1
  buffer_load_dwordx4 v[128:131], v2, s[20:23], s4 offen sc1
  buffer_load_dwordx4 v[132:135], v3, s[20:23], s4 offen sc1
  buffer_load_dwordx4 v[136:139], v4, s[20:23], s4 offen sc1
  s_waitcnt vmcnt(20)
  v_mfma_f32_16x16x32_bf16 v[12:15], a[12:15], v[140:143], v[12:15]
  v_mfma_f32_16x16x32_bf16 v[24:27], a[12:15], v[144:147], v[24:27]
  v_mfma_f32_16x16x32_bf16 v[36:39], a[12:15], v[148:151], v[36:39]
  v_mfma_f32_16x16x32_bf16 v[48:51], a[12:15], v[152:155], v[48:51]
  v_mfma_f32_16x16x32_bf16 v[16:19], a[16:19], v[140:143], v[16:19]
  v_mfma_f32_16x16x32_bf16 v[28:31], a[16:19], v[144:147], v[28:31]
  v_mfma_f32_16x16x32_bf16 v[40:43], a[16:19], v[148:151], v[40:43]
  v_mfma_f32_16x16x32_bf16 v[52:55], a[16:19], v[152:155], v[52:55]
  v_mfma_f32_16x16x32_bf16 v[20:23], a[20:23], v[140:143], v[20:23]
  v_mfma_f32_16x16x32_bf16 v[32:35], a[20:23], v[144:147], v[32:35]
  v_mfma_f32_16x16x32_bf16 v[44:47], a[20:23], v[148:151], v[44:47]
  v_mfma_f32_16x16x32_bf16 v[56:59], a[20:23], v[152:155], v[56:59]
  buffer_load_dwordx4 v[140:143], v1, s[20:23], s4 offen offset:1024 sc1
  buffer_load_dwordx4 v[144:147], v2, s[20:23], s4 offen offset:1024 sc1
  buffer_load_dwordx4 v[148:151], v3, s[20:23], s4 offen offset:1024 sc1
  buffer_load_dwordx4 v[152:155], v4, s[20:23], s4 offen offset:1024 sc1
  s_waitcnt vmcnt(20)
  v_mfma_f32_16x16x32_bf16 v[12:15], a[24:27], v[60:63], v[12:15]
  v_mfma_f32_16x16x32_bf16 v[24:27], a[24:27], v[64:67], v[24:27]
  v_mfma_f32_16x16x32_bf16 v[36:39], a[24:27], v[68:71], v[36:39]
  v_mfma_f32_16x16x32_bf16 v[48:51], a[24:27], v[72:75], v[48:51]
  v_mfma_f32_16x16x32_bf16 v[16:19], a[28:31], v[60:63], v[16:19]
  v_mfma_f32_16x16x32_bf16 v[28:31], a[28:31], v[64:67], v[28:31]
  v_mfma_f32_16x16x32_bf16 v[40:43], a[28:31], v[68:71], v[40:43]
  v_mfma_f32_16x16x32_bf16 v[52:55], a[28:31], v[72:75], v[52:55]
  v_mfma_f32_16x16x32_bf16 v[20:23], a[32:35], v[60:63], v[20:23]
  v_mfma_f32_16x16x32_bf16 v[32:35], a[32:35], v[64:67], v[32:35]
  v_mfma_f32_16x16x32_bf16 v[44:47], a[32:35], v[68:71], v[44:47]
  v_mfma_f32_16x16x32_bf16 v[56:59], a[32:35], v[72:75], v[56:59]
  buffer_load_dwordx4 v[60:63], v1, s[20:23], s4 offen offset:2048 sc1
  buffer_load_dwordx4 v[64:67], v2, s[20:23], s4 offen offset:2048 sc1
  buffer_load_dwordx4 v[68:71], v3, s[20:23], s4 offen offset:2048 sc1
  buffer_load_dwordx4 v[72:75], v4, s[20:23], s4 offen offset:2048 sc1
  s_waitcnt vmcnt(20)
  v_mfma_f32_16x16x32_bf16 v[12:15], a[36:39], v[76:79], v[12:15]
  v_mfma_f32_16x16x32_bf16 v[24:27], a[36:39], v[80:83], v[24:27]
  v_mfma_f32_16x16x32_bf16 v[36:39], a[36:39], v[84:87], v[36:39]
  v_mfma_f32_16x16x32_bf16 v[48:51], a[36:39], v[88:91], v[48:51]
  v_mfma_f32_16x16x32_bf16 v[16:19], a[40:43], v[76:79], v[16:19]
  v_mfma_f32_16x16x32_bf16 v[28:31], a[40:43], v[80:83], v[28:31]
  v_mfma_f32_16x16x32_bf16 v[40:43], a[40:43], v[84:87], v[40:43]
  v_mfma_f32_16x16x32_bf16 v[52:55], a[40:43], v[88:91], v[52:55]
  v_mfma_f32_16x16x32_bf16 v[20:23], a[44:47], v[76:79], v[20:23]
  v_mfma_f32_16x16x32_bf16 v[32:35], a[44:47], v[80:83], v[32:35]
  v_mfma_f32_16x16x32_bf16 v[44:47], a[44:47], v[84:87], v[44:47]
  v_mfma_f32_16x16x32_bf16 v[56:59], a[44:47], v[88:91], v[56:59]
  buffer_load_dwordx4 v[76:79], v1, s[20:23], s4 offen offset:3072 sc1
  buffer_load_dwordx4 v[80:83], v2, s[20:23], s4 offen offset:3072 sc1
  buffer_load_dwordx4 v[84:87], v3, s[20:23], s4 offen offset:3072 sc1
  buffer_load_dwordx4 v[88:91], v4, s[20:23], s4 offen offset:3072 sc1
  s_waitcnt vmcnt(20)
  v_mfma_f32_16x16x32_bf16 v[12:15], a[48:51], v[92:95], v[12:15]
  v_mfma_f32_16x16x32_bf16 v[24:27], a[48:51], v[96:99], v[24:27]
  v_mfma_f32_16x16x32_bf16 v[36:39], a[48:51], v[100:103], v[36:39]
  v_mfma_f32_16x16x32_bf16 v[48:51], a[48:51], v[104:107], v[48:51]
  v_mfma_f32_16x16x32_bf16 v[16:19], a[52:55], v[92:95], v[16:19]
  v_mfma_f32_16x16x32_bf16 v[28:31], a[52:55], v[96:99], v[28:31]
  v_mfma_f32_16x16x32_bf16 v[40:43], a[52:55], v[100:103], v[40:43]
  v_mfma_f32_16x16x32_bf16 v[52:55], a[52:55], v[104:107], v[52:55]
  v_mfma_f32_16x16x32_bf16 v[20:23], a[56:59], v[92:95], v[20:23]
  v_mfma_f32_16x16x32_bf16 v[32:35], a[56:59], v[96:99], v[32:35]
  v_mfma_f32_16x16x32_bf16 v[44:47], a[56:59], v[100:103], v[44:47]
  v_mfma_f32_16x16x32_bf16 v[56:59], a[56:59], v[104:107], v[56:59]
  s_add_u32 s4, s4, 4096
  buffer_load_dwordx4 v[92:95], v1, s[20:23], s4 offen sc1
  buffer_load_dwordx4 v[96:99], v2, s[20:23], s4 offen sc1
  buffer_load_dwordx4 v[100:103], v3, s[20:23], s4 offen sc1
  buffer_load_dwordx4 v[104:107], v4, s[20:23], s4 offen sc1
  s_waitcnt vmcnt(20)
  v_mfma_f32_16x16x32_bf16 v[12:15], a[60:63], v[108:111], v[12:15]
  v_mfma_f32_16x16x32_bf16 v[24:27], a[60:63], v[112:115], v[24:27]
  v_mfma_f32_16x16x32_bf16 v[36:39], a[60:63], v[116:119], v[36:39]
  v_mfma_f32_16x16x32_bf16 v[48:51], a[60:63], v[120:123], v[48:51]
  v_mfma_f32_16x16x32_bf16 v[16:19], a[64:67], v[108:111], v[16:19]
  v_mfma_f32_16x16x32_bf16 v[28:31], a[64:67], v[112:115], v[28:31]
  v_mfma_f32_16x16x32_bf16 v[40:43], a[64:67], v[116:119], v[40:43]
  v_mfma_f32_16x16x32_bf16 v[52:55], a[64:67], v[120:123], v[52:55]
  v_mfma_f32_16x16x32_bf16 v[20:23], a[68:71], v[108:111], v[20:23]
  v_mfma_f32_16x16x32_bf16 v[32:35], a[68:71], v[112:115], v[32:35]
  v_mfma_f32_16x16x32_bf16 v[44:47], a[68:71], v[116:119], v[44:47]
  v_mfma_f32_16x16x32_bf16 v[56:59], a[68:71], v[120:123], v[56:59]
  buffer_load_dwordx4 v[108:111], v1, s[20:23], s4 offen offset:1024 sc1
  buffer_load_dwordx4 v[112:115], v2, s[20:23], s4 offen offset:1024 sc1
  buffer_load_dwordx4 v[116:119], v3, s[20:23], s4 offen offset:1024 sc1
  buffer_load_dwordx4 v[120:123], v4, s[20:23], s4 offen offset:1024 sc1
  s_waitcnt vmcnt(20)
  v_mfma_f32_16x16x32_bf16 v[12:15], a[72:75], v[124:127], v[12:15]
  v_mfma_f32_16x16x32_bf16 v[24:27], a[72:75], v[128:131], v[24:27]
  v_mfma_f32_16x16x32_bf16 v[36:39], a[72:75], v[132:135], v[36:39]
  v_mfma_f32_16x16x32_bf16 v[48:51], a[72:75], v[136:139], v[48:51]
  v_mfma_f32_16x16x32_bf16 v[16:19], a[76:79], v[124:127], v[16:19]
  v_mfma_f32_16x16x32_bf16 v[28:31], a[76:79], v[128:131], v[28:31]
  v_mfma_f32_16x16x32_bf16 v[40:43], a[76:79], v[132:135], v[40:43]
  v_mfma_f32_16x16x32_bf16 v[52:55], a[76:79], v[136:139], v[52:55]
  v_mfma_f32_16x16x32_bf16 v[20:23], a[80:83], v[124:127], v[20:23]
  v_mfma_f32_16x16x32_bf16 v[32:35], a[80:83], v[128:131], v[32:35]
  v_mfma_f32_16x16x32_bf16 v[44:47], a[80:83], v[132:135], v[44:47]
  v_mfma_f32_16x16x32_bf16 v[56:59], a[80:83], v[136:139], v[56:59]
  buffer_load_dwordx4 v[124:127], v1, s[20:23], s4 offen offset:2048 sc1
  buffer_load_dwordx4 v[128:131], v2, s[20:23], s4 offen offset:2048 sc1
  buffer_load_dwordx4 v[132:135], v3, s[20:23], s4 offen offset:2048 sc1
  buffer_load_dwordx4 v[136:139], v4, s[20:23], s4 offen offset:2048 sc1
  s_waitcnt vmcnt(20)
  v_mfma_f32_16x16x32_bf16 v[12:15], a[84:87], v[140:143], v[12:15]
  v_mfma_f32_16x16x32_bf16 v[24:27], a[84:87], v[144:147], v[24:27]
  v_mfma_f32_16x16x32_bf16 v[36:39], a[84:87], v[148:151], v[36:39]
  v_mfma_f32_16x16x32_bf16 v[48:51], a[84:87], v[152:155], v[48:51]
  v_mfma_f32_16x16x32_bf16 v[16:19], a[88:91], v[140:143], v[16:19]
  v_mfma_f32_16x16x32_bf16 v[28:31], a[88:91], v[144:147], v[28:31]
  v_mfma_f32_16x16x32_bf16 v[40:43], a[88:91], v[148:151], v[40:43]
  v_mfma_f32_16x16x32_bf16 v[52:55], a[88:91], v[152:155], v[52:55]
  v_mfma_f32_16x16x32_bf16 v[20:23], a[92:95], v[140:143], v[20:23]
  v_mfma_f32_16x16x32_bf16 v[32:35], a[92:95], v[144:147], v[32:35]
  v_mfma_f32_16x16x32_bf16 v[44:47], a[92:95], v[148:151], v[44:47]
  v_mfma_f32_16x16x32_bf16 v[56:59], a[92:95], v[152:155], v[56:59]
  buffer_load_dwordx4 v[140:143], v1, s[20:23], s4 offen offset:3072 sc1
  buffer_load_dwordx4 v[144:147], v2, s[20:23], s4 offen offset:3072 sc1
  buffer_load_dwordx4 v[148:151], v3, s[20:23], s4 offen offset:3072 sc1
  buffer_load_dwordx4 v[152:155], v4, s[20:23], s4 offen offset:3072 sc1
  s_waitcnt vmcnt(20)
  v_mfma_f32_16x16x32_bf16 v[12:15], a[96:99], v[60:63], v[12:15]
  v_mfma_f32_16x16x32_bf16 v[24:27], a[96:99], v[64:67], v[24:27]
  v_mfma_f32_16x16x32_bf16 v[36:39], a[96:99], v[68:71], v[36:39]
  v_mfma_f32_16x16x32_bf16 v[48:51], a[96:99], v[72:75], v[48:51]
  v_mfma_f32_16x16x32_bf16 v[16:19], a[100:103], v[60:63], v[16:19]
  v_mfma_f32_16x16x32_bf16 v[28:31], a[100:103], v[64:67], v[28:31]
  v_mfma_f32_16x16x32_bf16 v[40:43], a[100:103], v[68:71], v[40:43]
  v_mfma_f32_16x16x32_bf16 v[52:55], a[100:103], v[72:75], v[52:55]
  v_mfma_f32_16x16x32_bf16 v[20:23], a[104:107], v[60:63], v[20:23]
  v_mfma_f32_16x16x32_bf16 v[32:35], a[104:107], v[64:67], v[32:35]
  v_mfma_f32_16x16x32_bf16 v[44:47], a[104:107], v[68:71], v[44:47]
  v_mfma_f32_16x16x32_bf16 v[56:59], a[104:107], v[72:75], v[56:59]
  s_add_u32 s4, s4, 4096
  buffer_load_dwordx4 v[60:63], v1, s[20:23], s4 offen sc1
  buffer_load_dwordx4 v[64:67], v2, s[20:23], s4 offen sc1
  buffer_load_dwordx4 v[68:71], v3, s[20:23], s4 offen sc1
  buffer_load_dwordx4 v[72:75], v4, s[20:23], s4 offen sc1
  s_waitcnt vmcnt(20)
  v_mfma_f32_16x16x32_bf16 v[12:15], a[108:111], v[76:79], v[12:15]
  v_mfma_f32_16x16x32_bf16 v[24:27], a[108:111], v[80:83], v[24:27]
  v_mfma_f32_16x16x32_bf16 v[36:39], a[108:111], v[84:87], v[36:39]
  v_mfma_f32_16x16x32_bf16 v[48:51], a[108:111], v[88:91], v[48:51]
  v_mfma_f32_16x16x32_bf16 v[16:19], a[112:115], v[76:79], v[16:19]
  v_mfma_f32_16x16x32_bf16 v[28:31], a[112:115], v[80:83], v[28:31]
  v_mfma_f32_16x16x32_bf16 v[40:43], a[112:115], v[84:87], v[40:43]
  v_mfma_f32_16x16x32_bf16 v[52:55], a[112:115], v[88:91], v[52:55]
  v_mfma_f32_16x16x32_bf16 v[20:23], a[116:119], v[76:79], v[20:23]
  v_mfma_f32_16x16x32_bf16 v[32:35], a[116:119], v[80:83], v[32:35]
  v_mfma_f32_16x16x32_bf16 v[44:47], a[116:119], v[84:87], v[44:47]
  v_mfma_f32_16x16x32_bf16 v[56:59], a[116:119], v[88:91], v[56:59]
  buffer_load_dwordx4 v[76:79], v1, s[20:23], s4 offen offset:1024 sc1
  buffer_load_dwordx4 v[80:83], v2, s[20:23], s4 offen offset:1024 sc1
  buffer_load_dwordx4 v[84:87], v3, s[20:23], s4 offen offset:1024 sc1
  buffer_load_dwordx4 v[88:91], v4, s[20:23], s4 offen offset:1024 sc1
  s_waitcnt vmcnt(20)
  v_mfma_f32_16x16x32_bf16 v[12:15], a[120:123], v[92:95], v[12:15]
  v_mfma_f32_16x16x32_bf16 v[24:27], a[120:123], v[96:99], v[24:27]
  v_mfma_f32_16x16x32_bf16 v[36:39], a[120:123], v[100:103], v[36:39]
  v_mfma_f32_16x16x32_bf16 v[48:51], a[120:123], v[104:107], v[48:51]
  v_mfma_f32_16x16x32_bf16 v[16:19], a[124:127], v[92:95], v[16:19]
  v_mfma_f32_16x16x32_bf16 v[28:31], a[124:127], v[96:99], v[28:31]
  v_mfma_f32_16x16x32_bf16 v[40:43], a[124:127], v[100:103], v[40:43]
  v_mfma_f32_16x16x32_bf16 v[52:55], a[124:127], v[104:107], v[52:55]
  v_mfma_f32_16x16x32_bf16 v[20:23], a[128:131], v[92:95], v[20:23]
  v_mfma_f32_16x16x32_bf16 v[32:35], a[128:131], v[96:99], v[32:35]
  v_mfma_f32_16x16x32_bf16 v[44:47], a[128:131], v[100:103], v[44:47]
  v_mfma_f32_16x16x32_bf16 v[56:59], a[128:131], v[104:107], v[56:59]
  buffer_load_dwordx4 v[92:95], v1, s[20:23], s4 offen offset:2048 sc1
  buffer_load_dwordx4 v[96:99], v2, s[20:23], s4 offen offset:2048 sc1
  buffer_load_dwordx4 v[100:103], v3, s[20:23], s4 offen offset:2048 sc1
  buffer_load_dwordx4 v[104:107], v4, s[20:23], s4 offen offset:2048 sc1
  s_waitcnt vmcnt(20) lgkmcnt(0)
  v_mfma_f32_16x16x32_bf16 v[12:15], a[132:135], v[108:111], v[12:15]
  v_mfma_f32_16x16x32_bf16 v[24:27], a[132:135], v[112:115], v[24:27]
  v_mfma_f32_16x16x32_bf16 v[36:39], a[132:135], v[116:119], v[36:39]
  v_mfma_f32_16x16x32_bf16 v[48:51], a[132:135], v[120:123], v[48:51]
  v_mfma_f32_16x16x32_bf16 v[16:19], a[136:139], v[108:111], v[16:19]
  v_mfma_f32_16x16x32_bf16 v[28:31], a[136:139], v[112:115], v[28:31]
  v_mfma_f32_16x16x32_bf16 v[40:43], a[136:139], v[116:119], v[40:43]
  v_mfma_f32_16x16x32_bf16 v[52:55], a[136:139], v[120:123], v[52:55]
  v_mfma_f32_16x16x32_bf16 v[20:23], a[140:143], v[108:111], v[20:23]
  v_mfma_f32_16x16x32_bf16 v[32:35], a[140:143], v[112:115], v[32:35]
  v_mfma_f32_16x16x32_bf16 v[44:47], a[140:143], v[116:119], v[44:47]
  v_mfma_f32_16x16x32_bf16 v[56:59], a[140:143], v[120:123], v[56:59]
  buffer_load_dwordx4 v[108:111], v1, s[20:23], s4 offen offset:3072 sc1
  buffer_load_dwordx4 v[112:115], v2, s[20:23], s4 offen offset:3072 sc1
  buffer_load_dwordx4 v[116:119], v3, s[20:23], s4 offen offset:3072 sc1
  buffer_load_dwordx4 v[120:123], v4, s[20:23], s4 offen offset:3072 sc1
  s_waitcnt vmcnt(20)
  v_mfma_f32_16x16x32_bf16 v[12:15], a[144:147], v[124:127], v[12:15]
  v_mfma_f32_16x16x32_bf16 v[24:27], a[144:147], v[128:131], v[24:27]
  v_mfma_f32_16x16x32_bf16 v[36:39], a[144:147], v[132:135], v[36:39]
  v_mfma_f32_16x16x32_bf16 v[48:51], a[144:147], v[136:139], v[48:51]
  v_mfma_f32_16x16x32_bf16 v[16:19], a[148:151], v[124:127], v[16:19]
  v_mfma_f32_16x16x32_bf16 v[28:31], a[148:151], v[128:131], v[28:31]
  v_mfma_f32_16x16x32_bf16 v[40:43], a[148:151], v[132:135], v[40:43]
  v_mfma_f32_16x16x32_bf16 v[52:55], a[148:151], v[136:139], v[52:55]
  v_mfma_f32_16x16x32_bf16 v[20:23], a[152:155], v[124:127], v[20:23]
  v_mfma_f32_16x16x32_bf16 v[32:35], a[152:155], v[128:131], v[32:35]
  v_mfma_f32_16x16x32_bf16 v[44:47], a[152:155], v[132:135], v[44:47]
  v_mfma_f32_16x16x32_bf16 v[56:59], a[152:155], v[136:139], v[56:59]
  s_add_u32 s4, s4, 4096
  buffer_load_dwordx4 v[124:127], v1, s[20:23], s4 offen sc1
  buffer_load_dwordx4 v[128:131], v2, s[20:23], s4 offen sc1
  buffer_load_dwordx4 v[132:135], v3, s[20:23], s4 offen sc1
  buffer_load_dwordx4 v[136:139], v4, s[20:23], s4 offen sc1
  s_waitcnt vmcnt(20)
  v_mfma_f32_16x16x32_bf16 v[12:15], a[156:159], v[140:143], v[12:15]
  v_mfma_f32_16x16x32_bf16 v[24:27], a[156:159], v[144:147], v[24:27]
  v_mfma_f32_16x16x32_bf16 v[36:39], a[156:159], v[148:151], v[36:39]
  v_mfma_f32_16x16x32_bf16 v[48:51], a[156:159], v[152:155], v[48:51]
  v_mfma_f32_16x16x32_bf16 v[16:19], a[160:163], v[140:143], v[16:19]
  v_mfma_f32_16x16x32_bf16 v[28:31], a[160:163], v[144:147], v[28:31]
  v_mfma_f32_16x16x32_bf16 v[40:43], a[160:163], v[148:151], v[40:43]
  v_mfma_f32_16x16x32_bf16 v[52:55], a[160:163], v[152:155], v[52:55]
  v_mfma_f32_16x16x32_bf16 v[20:23], a[164:167], v[140:143], v[20:23]
  v_mfma_f32_16x16x32_bf16 v[32:35], a[164:167], v[144:147], v[32:35]
  v_mfma_f32_16x16x32_bf16 v[44:47], a[164:167], v[148:151], v[44:47]
  v_mfma_f32_16x16x32_bf16 v[56:59], a[164:167], v[152:155], v[56:59]
  buffer_load_dwordx4 v[140:143], v1, s[20:23], s4 offen offset:1024 sc1
  buffer_load_dwordx4 v[144:147], v2, s[20:23], s4 offen offset:1024 sc1
  buffer_load_dwordx4 v[148:151], v3, s[20:23], s4 offen offset:1024 sc1
  buffer_load_dwordx4 v[152:155], v4, s[20:23], s4 offen offset:1024 sc1
  s_waitcnt vmcnt(20)
  v_mfma_f32_16x16x32_bf16 v[12:15], v[160:163], v[60:63], v[12:15]
  v_mfma_f32_16x16x32_bf16 v[24:27], v[160:163], v[64:67], v[24:27]
  v_mfma_f32_16x16x32_bf16 v[36:39], v[160:163], v[68:71], v[36:39]
  v_mfma_f32_16x16x32_bf16 v[48:51], v[160:163], v[72:75], v[48:51]
  v_mfma_f32_16x16x32_bf16 v[16:19], v[164:167], v[60:63], v[16:19]
  v_mfma_f32_16x16x32_bf16 v[28:31], v[164:167], v[64:67], v[28:31]
  v_mfma_f32_16x16x32_bf16 v[40:43], v[164:167], v[68:71], v[40:43]
  v_mfma_f32_16x16x32_bf16 v[52:55], v[164:167], v[72:75], v[52:55]
  v_mfma_f32_16x16x32_bf16 v[20:23], v[168:171], v[60:63], v[20:23]
  v_mfma_f32_16x16x32_bf16 v[32:35], v[168:171], v[64:67], v[32:35]
  v_mfma_f32_16x16x32_bf16 v[44:47], v[168:171], v[68:71], v[44:47]
  v_mfma_f32_16x16x32_bf16 v[56:59], v[168:171], v[72:75], v[56:59]
  buffer_load_dwordx4 v[60:63], v1, s[20:23], s4 offen offset:2048 sc1
  buffer_load_dwordx4 v[64:67], v2, s[20:23], s4 offen offset:2048 sc1
  buffer_load_dwordx4 v[68:71], v3, s[20:23], s4 offen offset:2048 sc1
  buffer_load_dwordx4 v[72:75], v4, s[20:23], s4 offen offset:2048 sc1
  s_waitcnt vmcnt(20)
  v_mfma_f32_16x16x32_bf16 v[12:15], v[172:175], v[76:79], v[12:15]
  v_mfma_f32_16x16x32_bf16 v[24:27], v[172:175], v[80:83], v[24:27]
  v_mfma_f32_16x16x32_bf16 v[36:39], v[172:175], v[84:87], v[36:39]
  v_mfma_f32_16x16x32_bf16 v[48:51], v[172:175], v[88:91], v[48:51]
  v_mfma_f32_16x16x32_bf16 v[16:19], v[176:179], v[76:79], v[16:19]
  v_mfma_f32_16x16x32_bf16 v[28:31], v[176:179], v[80:83], v[28:31]
  v_mfma_f32_16x16x32_bf16 v[40:43], v[176:179], v[84:87], v[40:43]
  v_mfma_f32_16x16x32_bf16 v[52:55], v[176:179], v[88:91], v[52:55]
  v_mfma_f32_16x16x32_bf16 v[20:23], v[180:183], v[76:79], v[20:23]
  v_mfma_f32_16x16x32_bf16 v[32:35], v[180:183], v[80:83], v[32:35]
  v_mfma_f32_16x16x32_bf16 v[44:47], v[180:183], v[84:87], v[44:47]
  v_mfma_f32_16x16x32_bf16 v[56:59], v[180:183], v[88:91], v[56:59]
  buffer_load_dwordx4 v[76:79], v1, s[20:23], s4 offen offset:3072 sc1
  buffer_load_dwordx4 v[80:83], v2, s[20:23], s4 offen offset:3072 sc1
  buffer_load_dwordx4 v[84:87], v3, s[20:23], s4 offen offset:3072 sc1
  buffer_load_dwordx4 v[88:91], v4, s[20:23], s4 offen offset:3072 sc1
  s_waitcnt vmcnt(20)
  v_mfma_f32_16x16x32_bf16 v[12:15], v[184:187], v[92:95], v[12:15]
  v_mfma_f32_16x16x32_bf16 v[24:27], v[184:187], v[96:99], v[24:27]
  v_mfma_f32_16x16x32_bf16 v[36:39], v[184:187], v[100:103], v[36:39]
  v_mfma_f32_16x16x32_bf16 v[48:51], v[184:187], v[104:107], v[48:51]
  v_mfma_f32_16x16x32_bf16 v[16:19], v[188:191], v[92:95], v[16:19]
  v_mfma_f32_16x16x32_bf16 v[28:31], v[188:191], v[96:99], v[28:31]
  v_mfma_f32_16x16x32_bf16 v[40:43], v[188:191], v[100:103], v[40:43]
  v_mfma_f32_16x16x32_bf16 v[52:55], v[188:191], v[104:107], v[52:55]
  v_mfma_f32_16x16x32_bf16 v[20:23], v[192:195], v[92:95], v[20:23]
  v_mfma_f32_16x16x32_bf16 v[32:35], v[192:195], v[96:99], v[32:35]
  v_mfma_f32_16x16x32_bf16 v[44:47], v[192:195], v[100:103], v[44:47]
  v_mfma_f32_16x16x32_bf16 v[56:59], v[192:195], v[104:107], v[56:59]
  s_waitcnt vmcnt(16)
  v_mfma_f32_16x16x32_bf16 v[12:15], v[196:199], v[108:111], v[12:15]
  v_mfma_f32_16x16x32_bf16 v[24:27], v[196:199], v[112:115], v[24:27]
  v_mfma_f32_16x16x32_bf16 v[36:39], v[196:199], v[116:119], v[36:39]
  v_mfma_f32_16x16x32_bf16 v[48:51], v[196:199], v[120:123], v[48:51]
  v_mfma_f32_16x16x32_bf16 v[16:19], v[200:203], v[108:111], v[16:19]
  v_mfma_f32_16x16x32_bf16 v[28:31], v[200:203], v[112:115], v[28:31]
  v_mfma_f32_16x16x32_bf16 v[40:43], v[200:203], v[116:119], v[40:43]
  v_mfma_f32_16x16x32_bf16 v[52:55], v[200:203], v[120:123], v[52:55]
  v_mfma_f32_16x16x32_bf16 v[20:23], v[204:207], v[108:111], v[20:23]
  v_mfma_f32_16x16x32_bf16 v[32:35], v[204:207], v[112:115], v[32:35]
  v_mfma_f32_16x16x32_bf16 v[44:47], v[204:207], v[116:119], v[44:47]
  v_mfma_f32_16x16x32_bf16 v[56:59], v[204:207], v[120:123], v[56:59]
  s_waitcnt vmcnt(12)
  v_mfma_f32_16x16x32_bf16 v[12:15], v[208:211], v[124:127], v[12:15]
  v_mfma_f32_16x16x32_bf16 v[24:27], v[208:211], v[128:131], v[24:27]
  v_mfma_f32_16x16x32_bf16 v[36:39], v[208:211], v[132:135], v[36:39]
  v_mfma_f32_16x16x32_bf16 v[48:51], v[208:211], v[136:139], v[48:51]
  v_mfma_f32_16x16x32_bf16 v[16:19], v[212:215], v[124:127], v[16:19]
  v_mfma_f32_16x16x32_bf16 v[28:31], v[212:215], v[128:131], v[28:31]
  v_mfma_f32_16x16x32_bf16 v[40:43], v[212:215], v[132:135], v[40:43]
  v_mfma_f32_16x16x32_bf16 v[52:55], v[212:215], v[136:139], v[52:55]
  v_mfma_f32_16x16x32_bf16 v[20:23], v[216:219], v[124:127], v[20:23]
  v_mfma_f32_16x16x32_bf16 v[32:35], v[216:219], v[128:131], v[32:35]
  v_mfma_f32_16x16x32_bf16 v[44:47], v[216:219], v[132:135], v[44:47]
  v_mfma_f32_16x16x32_bf16 v[56:59], v[216:219], v[136:139], v[56:59]
  s_waitcnt vmcnt(8)
  v_mfma_f32_16x16x32_bf16 v[12:15], v[220:223], v[140:143], v[12:15]
  v_mfma_f32_16x16x32_bf16 v[24:27], v[220:223], v[144:147], v[24:27]
  v_mfma_f32_16x16x32_bf16 v[36:39], v[220:223], v[148:151], v[36:39]
  v_mfma_f32_16x16x32_bf16 v[48:51], v[220:223], v[152:155], v[48:51]
  v_mfma_f32_16x16x32_bf16 v[16:19], v[224:227], v[140:143], v[16:19]
  v_mfma_f32_16x16x32_bf16 v[28:31], v[224:227], v[144:147], v[28:31]
  v_mfma_f32_16x16x32_bf16 v[40:43], v[224:227], v[148:151], v[40:43]
  v_mfma_f32_16x16x32_bf16 v[52:55], v[224:227], v[152:155], v[52:55]
  v_mfma_f32_16x16x32_bf16 v[20:23], v[228:231], v[140:143], v[20:23]
  v_mfma_f32_16x16x32_bf16 v[32:35], v[228:231], v[144:147], v[32:35]
  v_mfma_f32_16x16x32_bf16 v[44:47], v[228:231], v[148:151], v[44:47]
  v_mfma_f32_16x16x32_bf16 v[56:59], v[228:231], v[152:155], v[56:59]
  s_waitcnt vmcnt(4)
  v_mfma_f32_16x16x32_bf16 v[12:15], v[232:235], v[60:63], v[12:15]
  v_mfma_f32_16x16x32_bf16 v[24:27], v[232:235], v[64:67], v[24:27]
  v_mfma_f32_16x16x32_bf16 v[36:39], v[232:235], v[68:71], v[36:39]
  v_mfma_f32_16x16x32_bf16 v[48:51], v[232:235], v[72:75], v[48:51]
  v_mfma_f32_16x16x32_bf16 v[16:19], v[236:239], v[60:63], v[16:19]
  v_mfma_f32_16x16x32_bf16 v[28:31], v[236:239], v[64:67], v[28:31]
  v_mfma_f32_16x16x32_bf16 v[40:43], v[236:239], v[68:71], v[40:43]
  v_mfma_f32_16x16x32_bf16 v[52:55], v[236:239], v[72:75], v[52:55]
  v_mfma_f32_16x16x32_bf16 v[20:23], v[240:243], v[60:63], v[20:23]
  v_mfma_f32_16x16x32_bf16 v[32:35], v[240:243], v[64:67], v[32:35]
  v_mfma_f32_16x16x32_bf16 v[44:47], v[240:243], v[68:71], v[44:47]
  v_mfma_f32_16x16x32_bf16 v[56:59], v[240:243], v[72:75], v[56:59]
  s_waitcnt vmcnt(0)
  v_mfma_f32_16x16x32_bf16 v[12:15], v[244:247], v[76:79], v[12:15]
  v_mfma_f32_16x16x32_bf16 v[24:27], v[244:247], v[80:83], v[24:27]
  v_mfma_f32_16x16x32_bf16 v[36:39], v[244:247], v[84:87], v[36:39]
  v_mfma_f32_16x16x32_bf16 v[48:51], v[244:247], v[88:91], v[48:51]
  v_mfma_f32_16x16x32_bf16 v[16:19], v[248:251], v[76:79], v[16:19]
  v_mfma_f32_16x16x32_bf16 v[28:31], v[248:251], v[80:83], v[28:31]
  v_mfma_f32_16x16x32_bf16 v[40:43], v[248:251], v[84:87], v[40:43]
  v_mfma_f32_16x16x32_bf16 v[52:55], v[248:251], v[88:91], v[52:55]
  v_mfma_f32_16x16x32_bf16 v[20:23], v[252:255], v[76:79], v[20:23]
  v_mfma_f32_16x16x32_bf16 v[32:35], v[252:255], v[80:83], v[32:35]
  v_mfma_f32_16x16x32_bf16 v[44:47], v[252:255], v[84:87], v[44:47]
  v_mfma_f32_16x16x32_bf16 v[56:59], v[252:255], v[88:91], v[56:59]
  s_mul_i32 s35, s24, 12288
  v_add_u32 v7, s35, v9
  s_mul_i32 s35, s24, 3072
  v_add_u32 v8, s35, v9
  s_nop 4
  ds_write_b128 v7, v[12:15] offset:0
  ds_write_b128 v7, v[16:19] offset:1024
  ds_write_b128 v7, v[20:23] offset:2048
  ds_write_b128 v7, v[24:27] offset:3072
  ds_write_b128 v7, v[28:31] offset:4096
  ds_write_b128 v7, v[32:35] offset:5120
  ds_write_b128 v7, v[36:39] offset:6144
  ds_write_b128 v7, v[40:43] offset:7168
  ds_write_b128 v7, v[44:47] offset:8192
  ds_write_b128 v7, v[48:51] offset:9216
  ds_write_b128 v7, v[52:55] offset:10240
  ds_write_b128 v7, v[56:59] offset:11264
  s_waitcnt lgkmcnt(0)
  s_barrier
  ds_read_b128 v[60:63], v8 offset:0
  ds_read_b128 v[64:67], v8 offset:12288
  ds_read_b128 v[68:71], v8 offset:24576
  ds_read_b128 v[72:75], v8 offset:36864
  ds_read_b128 v[76:79], v8 offset:1024
  ds_read_b128 v[80:83], v8 offset:13312
  ds_read_b128 v[84:87], v8 offset:25600
  ds_read_b128 v[88:91], v8 offset:37888
  ds_read_b128 v[92:95], v8 offset:2048
  ds_read_b128 v[96:99], v8 offset:14336
  ds_read_b128 v[100:103], v8 offset:26624
  ds_read_b128 v[104:107], v8 offset:38912
  s_waitcnt lgkmcnt(8)
  v_pk_add_f32 v[60:61], v[60:61], v[64:65]
  v_pk_add_f32 v[62:63], v[62:63], v[66:67]
  v_pk_add_f32 v[68:69], v[68:69], v[72:73]
  v_pk_add_f32 v[70:71], v[70:71], v[74:75]
  v_pk_add_f32 v[60:61], v[60:61], v[68:69]
  v_pk_add_f32 v[62:63], v[62:63], v[70:71]
  v_cvt_pk_bf16_f32 v60, v60, v61
  v_cvt_pk_bf16_f32 v61, v62, v63
  buffer_store_dwordx2 v[60:61], v5, s[88:91], 0 offen offset:0
  s_waitcnt lgkmcnt(4)
  v_pk_add_f32 v[76:77], v[76:77], v[80:81]
  v_pk_add_f32 v[78:79], v[78:79], v[82:83]
  v_pk_add_f32 v[84:85], v[84:85], v[88:89]
  v_pk_add_f32 v[86:87], v[86:87], v[90:91]
  v_pk_add_f32 v[76:77], v[76:77], v[84:85]
  v_pk_add_f32 v[78:79], v[78:79], v[86:87]
  v_cvt_pk_bf16_f32 v76, v76, v77
  v_cvt_pk_bf16_f32 v77, v78, v79
  buffer_store_dwordx2 v[76:77], v5, s[88:91], 0 offen offset:32
  s_waitcnt lgkmcnt(0)
  v_pk_add_f32 v[92:93], v[92:93], v[96:97]
  v_pk_add_f32 v[94:95], v[94:95], v[98:99]
  v_pk_add_f32 v[100:101], v[100:101], v[104:105]
  v_pk_add_f32 v[102:103], v[102:103], v[106:107]
  v_pk_add_f32 v[92:93], v[92:93], v[100:101]
  v_pk_add_f32 v[94:95], v[94:95], v[102:103]
  v_cvt_pk_bf16_f32 v92, v92, v93
  v_cvt_pk_bf16_f32 v93, v94, v95
  buffer_store_dwordx2 v[92:93], v5, s[88:91], 0 offen offset:64
  s_endpgm
L_nocons:
  s_waitcnt vmcnt(0)
  s_barrier
  s_cmp_lg_u32 s24, 0
  s_cbranch_scc1 L_a_end
  s_mov_b32 exec_hi, 0
  v_mov_b32 v7, 1
  v_lshlrev_b32 v8, 7, v17
  buffer_atomic_add v7, v8, s[20:23], s39 offen
  s_waitcnt vmcnt(0)
  s_endpgm
L_wspin:
  s_mov_b32 s36, 131072
L_wspin_loop:
  s_sleep 4
  buffer_load_dword v31, off, s[84:87], 0 sc1
  s_waitcnt vmcnt(0)
  v_readfirstlane_b32 s35, v31
  s_sub_u32 s36, s36, 1
  s_cmp_eq_u32 s36, 0
  s_cbranch_scc1 L_wok
  s_cmp_lg_u32 s35, 256
  s_cbranch_scc1 L_wspin_loop
  s_branch L_wok
L_a_end:
  s_endpgm
L_tail_end:
L_special:
  s_cmp_eq_u32 s32, 6
  s_cbranch_scc1 L_sp_raw
  s_cmp_eq_u32 s32, 5
  s_cbranch_scc1 L_sp_wof
  s_cmp_eq_u32 s32, 4
  s_cbranch_scc1 L_sp_arr
  buffer_load_dword v31, off, s[84:87], 0 sc1
  s_getpc_b64 s[10:11]
L_ct_tail:
  s_sub_u32 s10, s10, 12604
  s_subb_u32 s11, s11, 0
  v_lshrrev_b32 v250, 6, v0
  s_lshl_b32 s3, s37, 2
  v_and_b32 v251, 0, v0
  v_add_u32 v250, s3, v250
  v_lshlrev_b32 v250, 0, v250
  v_add_u32 v250, v250, v251
  v_add_u32 v250, 0, v250
  v_min_u32 v250, 98, v250
  v_lshlrev_b32 v250, 7, v250
  v_mov_b32 v251, s11
  v_add_co_u32 v250, vcc, s10, v250
  v_addc_co_u32 v251, vcc, 0, v251, vcc
  s_mov_b64 exec, 1
  global_load_dword a255, v[250:251], off
  s_mov_b64 exec, -1
  s_branch L_loop
L_sp_arr:
  s_cmp_lg_u32 s24, 0
  s_cbranch_scc1 L_loop
  s_mov_b64 exec, 1
  v_mov_b32 v248, 1
  buffer_atomic_add v248, off, s[84:87], 0
  s_mov_b64 exec, -1
  s_branch L_loop
L_sp_wof:
  ds_read_b64_tr_b16 a[212:213], v28 offset:0
  ds_read_b64_tr_b16 a[214:215], v28 offset:16384
  ds_read_b64_tr_b16 a[216:217], v28 offset:128
  ds_read_b64_tr_b16 a[218:219], v28 offset:16512
  ds_read_b64_tr_b16 a[220:221], v28 offset:256
  ds_read_b64_tr_b16 a[222:223], v28 offset:16640
  ds_read_b64_tr_b16 a[224:225], v28 offset:384
  ds_read_b64_tr_b16 a[226:227], v28 offset:16768
  ds_read_b64_tr_b16 a[228:229], v29 offset:0
  ds_read_b64_tr_b16 a[230:231], v29 offset:16384
  s_waitcnt lgkmcnt(8)
  buffer_store_dwordx4 a[212:215], v30, s[20:23], s96 offen sc1
  s_waitcnt lgkmcnt(6)
  buffer_store_dwordx4 a[216:219], v30, s[20:23], s97 offen sc1
  s_waitcnt lgkmcnt(4)
  buffer_store_dwordx4 a[220:223], v30, s[20:23], s98 offen sc1
  s_waitcnt lgkmcnt(2)
  buffer_store_dwordx4 a[224:227], v30, s[20:23], s99 offen sc1
  s_waitcnt lgkmcnt(0)
  buffer_store_dwordx4 a[228:231], v30, s[20:23], s100 offen sc1
  s_branch L_loop
L_sp_raw:
  s_mul_i32 s35, s25, 16384
  s_mul_i32 s36, s26, 4352
  s_add_u32 s35, s35, s36
  s_add_u32 m0, s35, 0x20000
  s_movk_i32 s36, 0
  buffer_load_dwordx4 v254, s[92:95], s36 offen lds
  s_movk_i32 s36, 1216
  buffer_load_dwordx4 v254, s[92:95], s36 offen offset:1088 lds
  s_movk_i32 s36, 2432
  buffer_load_dwordx4 v254, s[92:95], s36 offen offset:2176 lds
  s_movk_i32 s36, 3648
  buffer_load_dwordx4 v254, s[92:95], s36 offen offset:3264 lds
  s_mul_i32 s35, s26, 16384
  s_add_u32 m0, s35, 0x22400
  s_nop 0
  buffer_load_dwordx4 v255, s[92:95], 0 offen lds
  s_branch L_loop
L_fallback:
  s_mov_b32 s58, 1
  s_waitcnt vmcnt(0) lgkmcnt(0)
  s_barrier
  s_branch L_restart
L_fb_max:
  s_waitcnt vmcnt(0) lgkmcnt(0)
  s_barrier
  s_mul_i32 s35, s25, 20480
  s_add_u32 s35, s35, 0x1e000
  v_add_u32 v248, s35, v30
  ds_read_b128 a[132:135], v248 offset:0
  ds_read_b128 a[136:139], v248 offset:1024
  ds_read_b128 a[140:143], v248 offset:2048
  ds_read_b128 a[144:147], v248 offset:3072
  s_waitcnt lgkmcnt(0)
  ds_read_b128 a[148:151], v248 offset:4096
  ds_read_b128 a[152:155], v248 offset:5120
  ds_read_b128 a[156:159], v248 offset:6144
  ds_read_b128 a[160:163], v248 offset:7168
  s_waitcnt lgkmcnt(0)
  ds_read_b128 a[164:167], v248 offset:8192
  ds_read_b128 a[168:171], v248 offset:9216
  ds_read_b128 a[172:175], v248 offset:10240
  ds_read_b128 a[176:179], v248 offset:11264
  s_waitcnt lgkmcnt(0)
  ds_read_b128 a[180:183], v248 offset:12288
  ds_read_b128 a[184:187], v248 offset:13312
  ds_read_b128 a[188:191], v248 offset:14336
  ds_read_b128 a[192:195], v248 offset:15360
  s_waitcnt lgkmcnt(0)
  ds_read_b128 a[196:199], v248 offset:16384
  ds_read_b128 a[200:203], v248 offset:17408
  ds_read_b128 a[204:207], v248 offset:18432
  ds_read_b128 a[208:211], v248 offset:19456
  s_waitcnt lgkmcnt(0)
  v_mov_b32 v248, 0xff800000
  v_mov_b32 v249, 0xff800000
  v_mov_b32 v250, 0xff800000
  v_mov_b32 v251, 0xff800000
  v_mov_b32 v252, 0xff800000
  v_mov_b64 v[112:113], 0
  v_mov_b64 v[114:115], 0
  v_mov_b64 v[116:117], 0
  v_mov_b64 v[118:119], 0
  v_mov_b64 v[120:121], 0
  v_mov_b64 v[122:123], 0
  v_mov_b64 v[124:125], 0
  v_mov_b64 v[126:127], 0
  v_mov_b64 v[128:129], 0
  v_mov_b64 v[130:131], 0
  s_mov_b32 s14, 0x80000
  s_mov_b32 s18, 0x80000
  s_mov_b32 s28, 0
  s_mov_b32 s29, 0x2000
L_fb_loop:
  s_add_u32 m0, s27, 0x0
  s_nop 0
  buffer_load_dwordx4 v1, s[12:15], s28 offen nt lds
  buffer_load_dwordx4 v2, s[12:15], s28 offen offset:1024 nt lds
  s_add_u32 m0, s27, 0x2000
  s_nop 0
  buffer_load_dwordx4 v1, s[12:15], s29 offen nt lds
  buffer_load_dwordx4 v2, s[12:15], s29 offen offset:1024 nt lds
  s_waitcnt vmcnt(0)
  s_barrier
  ds_read_b128 v[212:215], v5 offset:0
  ds_read_b128 v[216:219], v6 offset:0
  ds_read_b128 v[220:223], v7 offset:0
  ds_read_b128 v[224:227], v8 offset:0
  ds_read_b128 v[228:231], v5 offset:4096
  ds_read_b128 v[232:235], v6 offset:4096
  ds_read_b128 v[236:239], v7 offset:4096
  ds_read_b128 v[240:243], v8 offset:4096
  s_waitcnt lgkmcnt(0)
  s_barrier
  v_mfma_f32_16x16x32_bf16 v[32:35], v[212:215], a[132:135], v[112:115]
  v_mfma_f32_16x16x32_bf16 v[40:43], v[212:215], a[148:151], v[116:119]
  v_mfma_f32_16x16x32_bf16 v[48:51], v[212:215], a[164:167], v[120:123]
  v_mfma_f32_16x16x32_bf16 v[56:59], v[212:215], a[180:183], v[124:127]
  v_mfma_f32_16x16x32_bf16 v[64:67], v[212:215], a[196:199], v[128:131]
  v_mfma_f32_16x16x32_bf16 v[32:35], v[216:219], a[136:139], v[32:35]
  v_mfma_f32_16x16x32_bf16 v[40:43], v[216:219], a[152:155], v[40:43]
  v_mfma_f32_16x16x32_bf16 v[48:51], v[216:219], a[168:171], v[48:51]
  v_mfma_f32_16x16x32_bf16 v[56:59], v[216:219], a[184:187], v[56:59]
  v_mfma_f32_16x16x32_bf16 v[64:67], v[216:219], a[200:203], v[64:67]
  v_mfma_f32_16x16x32_bf16 v[32:35], v[220:223], a[140:143], v[32:35]
  v_mfma_f32_16x16x32_bf16 v[40:43], v[220:223], a[156:159], v[40:43]
  v_mfma_f32_16x16x32_bf16 v[48:51], v[220:223], a[172:175], v[48:51]
  v_mfma_f32_16x16x32_bf16 v[56:59], v[220:223], a[188:191], v[56:59]
  v_mfma_f32_16x16x32_bf16 v[64:67], v[220:223], a[204:207], v[64:67]
  v_mfma_f32_16x16x32_bf16 v[32:35], v[224:227], a[144:147], v[32:35]
  v_mfma_f32_16x16x32_bf16 v[40:43], v[224:227], a[160:163], v[40:43]
  v_mfma_f32_16x16x32_bf16 v[48:51], v[224:227], a[176:179], v[48:51]
  v_mfma_f32_16x16x32_bf16 v[56:59], v[224:227], a[192:195], v[56:59]
  v_mfma_f32_16x16x32_bf16 v[64:67], v[224:227], a[208:211], v[64:67]
  v_mfma_f32_16x16x32_bf16 v[36:39], v[228:231], a[132:135], v[112:115]
  v_mfma_f32_16x16x32_bf16 v[44:47], v[228:231], a[148:151], v[116:119]
  v_mfma_f32_16x16x32_bf16 v[52:55], v[228:231], a[164:167], v[120:123]
  v_mfma_f32_16x16x32_bf16 v[60:63], v[228:231], a[180:183], v[124:127]
  v_mfma_f32_16x16x32_bf16 v[68:71], v[228:231], a[196:199], v[128:131]
  v_mfma_f32_16x16x32_bf16 v[36:39], v[232:235], a[136:139], v[36:39]
  v_mfma_f32_16x16x32_bf16 v[44:47], v[232:235], a[152:155], v[44:47]
  v_mfma_f32_16x16x32_bf16 v[52:55], v[232:235], a[168:171], v[52:55]
  v_mfma_f32_16x16x32_bf16 v[60:63], v[232:235], a[184:187], v[60:63]
  v_mfma_f32_16x16x32_bf16 v[68:71], v[232:235], a[200:203], v[68:71]
  v_mfma_f32_16x16x32_bf16 v[36:39], v[236:239], a[140:143], v[36:39]
  v_mfma_f32_16x16x32_bf16 v[44:47], v[236:239], a[156:159], v[44:47]
  v_mfma_f32_16x16x32_bf16 v[52:55], v[236:239], a[172:175], v[52:55]
  v_mfma_f32_16x16x32_bf16 v[60:63], v[236:239], a[188:191], v[60:63]
  v_mfma_f32_16x16x32_bf16 v[68:71], v[236:239], a[204:207], v[68:71]
  v_mfma_f32_16x16x32_bf16 v[36:39], v[240:243], a[144:147], v[36:39]
  v_mfma_f32_16x16x32_bf16 v[44:47], v[240:243], a[160:163], v[44:47]
  v_mfma_f32_16x16x32_bf16 v[52:55], v[240:243], a[176:179], v[52:55]
  v_mfma_f32_16x16x32_bf16 v[60:63], v[240:243], a[192:195], v[60:63]
  v_mfma_f32_16x16x32_bf16 v[68:71], v[240:243], a[208:211], v[68:71]
  s_nop 7
  v_max3_f32 v248, v32, v33, v248
  v_max3_f32 v248, v34, v35, v248
  v_max3_f32 v248, v36, v37, v248
  v_max3_f32 v248, v38, v39, v248
  v_max3_f32 v249, v40, v41, v249
  v_max3_f32 v249, v42, v43, v249
  v_max3_f32 v249, v44, v45, v249
  v_max3_f32 v249, v46, v47, v249
  v_max3_f32 v250, v48, v49, v250
  v_max3_f32 v250, v50, v51, v250
  v_max3_f32 v250, v52, v53, v250
  v_max3_f32 v250, v54, v55, v250
  v_max3_f32 v251, v56, v57, v251
  v_max3_f32 v251, v58, v59, v251
  v_max3_f32 v251, v60, v61, v251
  v_max3_f32 v251, v62, v63, v251
  v_max3_f32 v252, v64, v65, v252
  v_max3_f32 v252, v66, v67, v252
  v_max3_f32 v252, v68, v69, v252
  v_max3_f32 v252, v70, v71, v252
  s_add_u32 s28, s28, 0x4000
  s_add_u32 s29, s29, 0x4000
  s_cmp_lt_u32 s28, 0x80000
  s_cbranch_scc1 L_fb_loop
  v_mov_b32 v253, v248
  s_nop 1
  v_permlane32_swap_b32 v248, v253
  s_nop 1
  v_max_f32 v248, v248, v253
  v_mov_b32 v253, v248
  s_nop 1
  v_permlane16_swap_b32 v248, v253
  s_nop 1
  v_max_f32 v248, v248, v253
  v_mov_b32 v253, v249
  s_nop 1
  v_permlane32_swap_b32 v249, v253
  s_nop 1
  v_max_f32 v249, v249, v253
  v_mov_b32 v253, v249
  s_nop 1
  v_permlane16_swap_b32 v249, v253
  s_nop 1
  v_max_f32 v249, v249, v253
  v_mov_b32 v253, v250
  s_nop 1
  v_permlane32_swap_b32 v250, v253
  s_nop 1
  v_max_f32 v250, v250, v253
  v_mov_b32 v253, v250
  s_nop 1
  v_permlane16_swap_b32 v250, v253
  s_nop 1
  v_max_f32 v250, v250, v253
  v_mov_b32 v253, v251
  s_nop 1
  v_permlane32_swap_b32 v251, v253
  s_nop 1
  v_max_f32 v251, v251, v253
  v_mov_b32 v253, v251
  s_nop 1
  v_permlane16_swap_b32 v251, v253
  s_nop 1
  v_max_f32 v251, v251, v253
  v_mov_b32 v253, v252
  s_nop 1
  v_permlane32_swap_b32 v252, v253
  s_nop 1
  v_max_f32 v252, v252, v253
  v_mov_b32 v253, v252
  s_nop 1
  v_permlane16_swap_b32 v252, v253
  s_nop 1
  v_max_f32 v252, v252, v253
  v_lshlrev_b32 v31, 2, v17
  s_mul_i32 s35, s24, 1280
  s_add_u32 s35, s35, 0x4000
  v_add_u32 v254, s35, v31
  s_xor_b32 s36, s24, 1
  s_mul_i32 s36, s36, 1280
  s_add_u32 s36, s36, 0x4000
  v_add_u32 v255, s36, v31
  ds_write_b32 v254, v248 offset:0
  ds_write_b32 v254, v249 offset:256
  ds_write_b32 v254, v250 offset:512
  ds_write_b32 v254, v251 offset:768
  ds_write_b32 v254, v252 offset:1024
  s_waitcnt lgkmcnt(0)
  s_barrier
  ds_read_b32 v32, v255 offset:0
  ds_read_b32 v33, v255 offset:256
  ds_read_b32 v34, v255 offset:512
  ds_read_b32 v35, v255 offset:768
  ds_read_b32 v36, v255 offset:1024
  s_waitcnt lgkmcnt(0)
  v_max_f32 v248, v248, v32
  v_sub_f32 v112, 0, v248
  v_sub_f32 v113, 0, v248
  v_sub_f32 v114, 0, v248
  v_sub_f32 v115, 0, v248
  v_max_f32 v249, v249, v33
  v_sub_f32 v116, 0, v249
  v_sub_f32 v117, 0, v249
  v_sub_f32 v118, 0, v249
  v_sub_f32 v119, 0, v249
  v_max_f32 v250, v250, v34
  v_sub_f32 v120, 0, v250
  v_sub_f32 v121, 0, v250
  v_sub_f32 v122, 0, v250
  v_sub_f32 v123, 0, v250
  v_max_f32 v251, v251, v35
  v_sub_f32 v124, 0, v251
  v_sub_f32 v125, 0, v251
  v_sub_f32 v126, 0, v251
  v_sub_f32 v127, 0, v251
  v_max_f32 v252, v252, v36
  v_sub_f32 v128, 0, v252
  v_sub_f32 v129, 0, v252
  v_sub_f32 v130, 0, v252
  v_sub_f32 v131, 0, v252
  v_mov_b64 v[240:241], 0
  v_mov_b64 v[242:243], 0
  s_nop 1
  v_mfma_f32_32x32x16_bf16 v[132:147], v[240:243], v[240:243], 0
  v_mfma_f32_32x32x16_bf16 v[148:163], v[240:243], v[240:243], 0
  v_mfma_f32_32x32x16_bf16 v[164:179], v[240:243], v[240:243], 0
  v_mfma_f32_32x32x16_bf16 v[180:195], v[240:243], v[240:243], 0
  v_mfma_f32_32x32x16_bf16 v[196:211], v[240:243], v[240:243], 0
  v_mfma_f32_32x32x16_bf16 a[0:15], v[240:243], v[240:243], 0
  v_mfma_f32_32x32x16_bf16 a[16:31], v[240:243], v[240:243], 0
  v_mfma_f32_32x32x16_bf16 a[32:47], v[240:243], v[240:243], 0
  v_mfma_f32_32x32x16_bf16 a[48:63], v[240:243], v[240:243], 0
  v_mfma_f32_32x32x16_bf16 a[64:79], v[240:243], v[240:243], 0
  v_mfma_f32_32x32x16_bf16 a[80:95], v[240:243], v[240:243], 0
  v_mfma_f32_16x16x32_bf16 a[96:99], v[240:243], v[240:243], 0
  s_barrier
  s_mov_b32 s28, 0x0
  s_add_u32 m0, s27, 0x0
  s_nop 0
  buffer_load_dwordx4 v1, s[12:15], s28 offen nt lds
  buffer_load_dwordx4 v2, s[12:15], s28 offen offset:1024 nt lds
  s_mov_b32 s29, 0x2000
  s_add_u32 m0, s27, 0x2000
  s_nop 0
  buffer_load_dwordx4 v1, s[12:15], s29 offen nt lds
  buffer_load_dwordx4 v2, s[12:15], s29 offen offset:1024 nt lds
  s_mov_b32 s28, 0x4000
  s_add_u32 m0, s27, 0x4000
  s_nop 0
  buffer_load_dwordx4 v1, s[12:15], s28 offen nt lds
  buffer_load_dwordx4 v2, s[12:15], s28 offen offset:1024 nt lds
  s_mov_b32 s29, 0x6000
  s_add_u32 m0, s27, 0x6000
  s_nop 0
  buffer_load_dwordx4 v1, s[12:15], s29 offen nt lds
  buffer_load_dwordx4 v2, s[12:15], s29 offen offset:1024 nt lds
  s_mov_b32 s101, 0x3
  s_waitcnt vmcnt(0)
  s_barrier
  s_branch L_qk0
.section .rodata,"a"
.p2align 6
.amdhsa_kernel standalone__gqa_block_cached__near_ridge_kernel
.amdhsa_next_free_vgpr 512
.amdhsa_next_free_sgpr 102
.amdhsa_accum_offset 256
.amdhsa_group_segment_fixed_size 0
.amdhsa_kernarg_size 64
.amdhsa_user_sgpr_count 2
.amdhsa_user_sgpr_kernarg_segment_ptr 1
.amdhsa_system_sgpr_workgroup_id_x 1
.end_amdhsa_kernel
```
